```python
import torch

def _softmax(x, axis=-1):
    return torch.softmax(x, dim=axis)
def _gelu(x):
    return torch.nn.functional.gelu(x, approximate="tanh")
def _silu(x):
    return torch.nn.functional.silu(x)
def _sigmoid(x):
    return torch.sigmoid(x)
def _layernorm(x, axis=-1, eps=1e-5):
    m = x.mean(dim=axis, keepdim=True)
    v = x.var(dim=axis, keepdim=True, unbiased=False)
    return (x - m) / torch.sqrt(v + eps)
def _scatter_add(tgt, idx, src, axis=0):
    return tgt.clone().index_add_(axis, idx, src)
def _segment_sum(src, seg, n):
    out = torch.zeros((n,) + src.shape[1:], dtype=src.dtype)
    return out.index_add_(0, seg, src)
def _pad(x, pw):
    flat = tuple(v for pair in reversed(pw) for v in pair)
    return torch.nn.functional.pad(x, flat)

kernel_name = 'concat_heads__grouped_kv_mqa__sliding_block__prompt'

def setup_inputs():

    _w = (lambda a: (lambda t: t.to(torch.bfloat16) if t.is_floating_point() else t)(torch.as_tensor(a)))
    def _A_setup():
        B, S, D, H = 1, 2048, 512, 32
        Dh = D // H
        return {
            "x": _w((lambda *s: torch.randn(*s, dtype=torch.bfloat16) * 0.05)(B, S, D)),
            "wq": _w((lambda *s: torch.randn(*s, dtype=torch.bfloat16) * 3.2)(D, H * Dh)),
            "wk": _w((lambda *s: torch.randn(*s, dtype=torch.bfloat16) * 3.2)(D, Dh)),
            "wv": _w((lambda *s: torch.randn(*s, dtype=torch.bfloat16) * 1.6)(D, Dh)),
            "wo": _w((lambda *s: torch.randn(*s, dtype=torch.bfloat16) * 1.6)(H * Dh, D)),
        }
    _A_in = _A_setup()

    def _B_setup():
        B, S, D = 1, 2048, 512
        return {
            "x": _w((lambda *s: torch.randn(*s, dtype=torch.bfloat16) * 0.1)(B, S, D)),
            "wqkv": _w((lambda *s: torch.randn(*s, dtype=torch.bfloat16) * 0.8)(D, 3 * D)),
            "wo": _w((lambda *s: torch.randn(*s, dtype=torch.bfloat16) * 0.8)(D, D)),
        }
    _B_in = _B_setup()

    return {
        "A_x": _A_in["x"],
        "A_wq": _A_in["wq"],
        "A_wk": _A_in["wk"],
        "A_wv": _A_in["wv"],
        "A_wo": _A_in["wo"],
        "B_x": _B_in["x"],
        "B_wqkv": _B_in["wqkv"],
        "B_wo": _B_in["wo"],
    }

def reference(A_x, A_wq, A_wk, A_wv, A_wo, B_x, B_wqkv, B_wo):
    def _A_ref(x, wq, wk, wv, wo):
        B, S, D = x.shape
        H = 32
        Dh = D // H
        q = (lambda x, *d: x.permute(*d))((x @ wq).reshape(B, S, H, Dh), 0, 2, 1, 3)
        k = x @ wk
        v = x @ wv
        scores = torch.einsum("bhqd,bkd->bhqk", q, k) * (Dh ** -0.5)
        p = _softmax(scores, axis=-1)
        o = torch.einsum("bhqk,bkd->bhqd", p, v)
        return (lambda x, *d: x.permute(*d))(o, 0, 2, 1, 3).reshape(B, S, H * Dh) @ wo

    def _B_ref(x, wqkv, wo):
        B, S, D = x.shape
        H = 32; Dh = D // H; W = 256
        qkv = (lambda x, *d: x.permute(*d))((x @ wqkv).reshape(B, S, 3, H, Dh), 2, 0, 3, 1, 4)
        q, k, v = qkv[0], qkv[1], qkv[2]
        scores = torch.einsum("bhqd,bhkd->bhqk", q, k) * (Dh ** -0.5)
        idx = torch.arange(S)
        mask = (idx[:, None] - idx[None, :] >= 0) & (idx[:, None] - idx[None, :] < W)
        scores = torch.where(mask[None, None], scores, -1e9)
        p = _softmax(scores, axis=-1)
        o = torch.einsum("bhqk,bhkd->bhqd", p, v)
        return (lambda x, *d: x.permute(*d))(o, 0, 2, 1, 3).reshape(B, S, D) @ wo

    a = _A_ref(A_x, A_wq, A_wk, A_wv, A_wo)
    b = _B_ref(B_x, B_wqkv, B_wo)
    return torch.concatenate([a, b], axis=-1)
```

```asm
; @launch kernel=proj_kernel grid=(256,1,1) block=(512,1,1) lds=147456
; @launch kernel=attn_kernel grid=(256,1,1) block=(512,1,1) lds=163840
.amdgcn_target "amdgcn-amd-amdhsa--gfx950"
.text
.globl proj_kernel
.p2align 8
.type proj_kernel,@function
proj_kernel:
    s_cmp_ge_u32 s2, 256
    s_cbranch_scc1 proj_kernel_end
    s_load_dwordx8 s[4:11], s[0:1], 0
    s_load_dwordx4 s[12:15], s[0:1], 40
    s_load_dwordx2 s[16:17], s[0:1], 80
    v_lshrrev_b32 v1, 6, v0
    v_and_b32 v0, 63, v0
    s_and_b32 s18, s2, 7
    v_readfirstlane_b32 s70, v1
    s_lshr_b32 s20, s2, 3
    s_and_b32 s21, s20, 3
    s_lshr_b32 s20, s20, 2
    s_and_b32 s19, s70, 3
    s_sub_u32 s23, s18, 2
    s_lshr_b32 s22, s23, 1
    s_add_u32 s22, s22, 1
    s_and_b32 s23, s18, 1
    s_cmp_lt_u32 s18, 2
    s_cselect_b32 s22, 0, s22
    s_lshl_b32 s23, s23, 3
    s_add_u32 s20, s20, s23
    s_waitcnt lgkmcnt(0)
    s_cmp_eq_u32 s22, 0
    s_cselect_b32 s24, s4, s12
    s_cselect_b32 s25, s5, s13
    s_cselect_b32 s26, s6, s14
    s_cselect_b32 s27, s7, s15
    s_cselect_b32 s28, 1, 3
    s_lshl_b32 s29, s28, 19
    s_lshl_b32 s28, s28, 10
    s_mov_b32 s40, s16
    s_and_b32 s41, s17, 0xffff
    s_mov_b32 s42, 0xd00000
    s_mov_b32 s43, 0x20000
    s_lshr_b32 s56, s19, 1
    s_and_b32 s58, s19, 1
    s_cmp_lt_u32 s70, 4
    s_cbranch_scc1 proj_kernel_comp
    s_setprio 1
    s_mov_b32 s32, s24
    s_and_b32 s33, s25, 0xffff
    s_mov_b32 s34, 0x200000
    s_mov_b32 s35, 0x20000
    s_mov_b32 s36, s26
    s_and_b32 s37, s27, 0xffff
    s_mov_b32 s38, s29
    s_mov_b32 s39, 0x20000
    v_lshrrev_b32 v1, 3, v0
    v_lshrrev_b32 v2, 4, v0
    v_and_b32 v3, 7, v0
    v_xor_b32 v3, v3, v2
    v_lshlrev_b32 v3, 4, v3
    v_lshl_add_u32 v4, v1, 10, v3
    v_xor_b32 v5, 64, v4
    v_add_u32 v5, 0x2000, v5
    s_lshl_b32 s48, s20, 17
    s_lshl_b32 s49, s19, 15
    s_add_u32 s48, s48, s49
    v_and_b32 v3, 15, v0
    v_lshlrev_b32 v1, 2, v2
    v_xor_b32 v3, v3, v1
    v_lshlrev_b32 v3, 4, v3
    v_mul_lo_u32 v1, v2, s28
    v_add_u32 v6, v1, v3
    s_max_u32 s50, s22, 1
    s_sub_u32 s50, s50, 1
    s_lshl_b32 s50, s50, 10
    s_lshl_b32 s51, s21, 8
    s_add_u32 s50, s50, s51
    s_lshl_b32 s51, s19, 4
    s_mul_i32 s51, s51, s28
    s_add_u32 s50, s50, s51
    s_lshl_b32 s51, s28, 2
    s_lshl_b32 s52, s28, 6
    v_lshlrev_b32 v7, 4, v0
    s_and_b32 s53, s19, 1
    s_lshl_b32 s53, s53, 10
    s_lshl_b32 s54, s19, 12
    s_lshl_b32 s55, s19, 10
    s_and_b32 s57, s20, 1
    s_mov_b32 s62, s54
    s_lshl_b32 s63, s57, 7
    s_add_u32 s63, s63, s48
    s_mul_i32 s64, s57, s52
    s_add_u32 s64, s64, s50
    s_lshl_b32 s65, s57, 11
    s_add_u32 s65, s65, s53
    s_cmp_eq_u32 s22, 0
    s_cbranch_scc1 proj_kernel_ldkv
    s_mov_b32 m0, s62
    s_add_u32 s68, s63, 0x4000
    buffer_load_dwordx4 v4, s[32:35], s63 offen lds
    s_add_u32 m0, s62, 0x10000
    s_add_u32 s66, s64, s51
    buffer_load_dwordx4 v6, s[36:39], s64 offen lds
    s_add_u32 m0, s62, 0x400
    s_add_u32 s64, s64, s52
    buffer_load_dwordx4 v5, s[32:35], s63 offen lds
    s_add_u32 m0, s62, 0x10400
    s_add_u32 s67, s66, s51
    buffer_load_dwordx4 v6, s[36:39], s66 offen lds
    s_add_u32 m0, s62, 0x800
    s_add_u32 s63, s63, 128
    buffer_load_dwordx4 v4, s[32:35], s68 offen lds
    s_add_u32 m0, s62, 0x10800
    s_add_u32 s66, s67, s51
    buffer_load_dwordx4 v6, s[36:39], s67 offen lds
    s_add_u32 m0, s62, 0xc00
    s_lshr_b32 s67, s62, 2
    buffer_load_dwordx4 v5, s[32:35], s68 offen lds
    s_add_u32 m0, s62, 0x10c00
    s_add_u32 s62, s62, 0x4000
    buffer_load_dwordx4 v6, s[36:39], s66 offen lds
    s_and_b32 s62, s62, 0xffff
    s_add_u32 s57, s57, 1
    s_cmp_eq_u32 s57, 8
    s_cselect_b32 s63, s48, s63
    s_cselect_b32 s64, s50, s64
    s_mov_b32 m0, s62
    s_add_u32 s68, s63, 0x4000
    buffer_load_dwordx4 v4, s[32:35], s63 offen lds
    s_add_u32 m0, s62, 0x10000
    s_add_u32 s66, s64, s51
    buffer_load_dwordx4 v6, s[36:39], s64 offen lds
    s_add_u32 m0, s62, 0x400
    s_add_u32 s64, s64, s52
    buffer_load_dwordx4 v5, s[32:35], s63 offen lds
    s_add_u32 m0, s62, 0x10400
    s_add_u32 s67, s66, s51
    buffer_load_dwordx4 v6, s[36:39], s66 offen lds
    s_add_u32 m0, s62, 0x800
    s_add_u32 s63, s63, 128
    buffer_load_dwordx4 v4, s[32:35], s68 offen lds
    s_add_u32 m0, s62, 0x10800
    s_add_u32 s66, s67, s51
    buffer_load_dwordx4 v6, s[36:39], s67 offen lds
    s_add_u32 m0, s62, 0xc00
    s_lshr_b32 s67, s62, 2
    buffer_load_dwordx4 v5, s[32:35], s68 offen lds
    s_add_u32 m0, s62, 0x10c00
    s_add_u32 s62, s62, 0x4000
    buffer_load_dwordx4 v6, s[36:39], s66 offen lds
    s_and_b32 s62, s62, 0xffff
    s_add_u32 s57, s57, 1
    s_cmp_eq_u32 s57, 8
    s_cselect_b32 s63, s48, s63
    s_cselect_b32 s64, s50, s64
    s_waitcnt vmcnt(8)
    s_barrier
    s_mov_b32 s69, 6
proj_kernel_l0_ll:
    s_mov_b32 m0, s62
    s_add_u32 s68, s63, 0x4000
    buffer_load_dwordx4 v4, s[32:35], s63 offen lds
    s_add_u32 m0, s62, 0x10000
    s_add_u32 s66, s64, s51
    buffer_load_dwordx4 v6, s[36:39], s64 offen lds
    s_add_u32 m0, s62, 0x400
    s_add_u32 s64, s64, s52
    buffer_load_dwordx4 v5, s[32:35], s63 offen lds
    s_add_u32 m0, s62, 0x10400
    s_add_u32 s67, s66, s51
    buffer_load_dwordx4 v6, s[36:39], s66 offen lds
    s_add_u32 m0, s62, 0x800
    s_add_u32 s63, s63, 128
    buffer_load_dwordx4 v4, s[32:35], s68 offen lds
    s_add_u32 m0, s62, 0x10800
    s_add_u32 s66, s67, s51
    buffer_load_dwordx4 v6, s[36:39], s67 offen lds
    s_add_u32 m0, s62, 0xc00
    s_lshr_b32 s67, s62, 2
    buffer_load_dwordx4 v5, s[32:35], s68 offen lds
    s_add_u32 m0, s62, 0x10c00
    s_add_u32 s62, s62, 0x4000
    buffer_load_dwordx4 v6, s[36:39], s66 offen lds
    s_and_b32 s62, s62, 0xffff
    s_add_u32 s57, s57, 1
    s_cmp_eq_u32 s57, 8
    s_cselect_b32 s63, s48, s63
    s_cselect_b32 s64, s50, s64
    s_waitcnt vmcnt(8)
    s_barrier
    s_sub_u32 s69, s69, 1
    s_cmp_lg_u32 s69, 0
    s_cbranch_scc1 proj_kernel_l0_ll
    s_waitcnt vmcnt(0)
    s_barrier
    s_endpgm
proj_kernel_ldkv:
    s_mov_b32 m0, s62
    s_add_u32 s68, s63, 0x4000
    buffer_load_dwordx4 v4, s[32:35], s63 offen lds
    s_add_u32 m0, s62, 0x10000
    s_add_u32 s66, s64, s51
    buffer_load_dwordx4 v6, s[36:39], s64 offen lds
    s_add_u32 m0, s62, 0x400
    s_add_u32 s64, s64, s52
    buffer_load_dwordx4 v5, s[32:35], s63 offen lds
    s_add_u32 m0, s62, 0x10400
    s_add_u32 s67, s66, s51
    buffer_load_dwordx4 v6, s[36:39], s66 offen lds
    s_add_u32 m0, s62, 0x800
    s_add_u32 s63, s63, 128
    buffer_load_dwordx4 v4, s[32:35], s68 offen lds
    s_add_u32 m0, s62, 0x10800
    s_add_u32 s66, s67, s51
    buffer_load_dwordx4 v6, s[36:39], s67 offen lds
    s_add_u32 m0, s62, 0xc00
    s_lshr_b32 s67, s62, 2
    buffer_load_dwordx4 v5, s[32:35], s68 offen lds
    s_add_u32 m0, s62, 0x10c00
    s_add_u32 s62, s62, 0x4000
    buffer_load_dwordx4 v6, s[36:39], s66 offen lds
    s_and_b32 s62, s62, 0xffff
    s_add_u32 s57, s57, 1
    s_cmp_eq_u32 s57, 8
    s_cselect_b32 s63, s48, s63
    s_cselect_b32 s64, s50, s64
    s_cmp_lt_u32 s19, 2
    s_cselect_b32 s30, s8, s10
    s_cselect_b32 s31, s9, s11
    s_mov_b32 s44, s30
    s_and_b32 s45, s31, 0xffff
    s_mov_b32 s46, 0x4000
    s_mov_b32 s47, 0x20000
    s_add_u32 m0, s67, 0x20000
    s_add_u32 s59, s65, 0x800
    buffer_load_dwordx4 v7, s[44:47], s65 offen lds
    s_and_b32 s65, s59, 0x3fff
    s_mov_b32 m0, s62
    s_add_u32 s68, s63, 0x4000
    buffer_load_dwordx4 v4, s[32:35], s63 offen lds
    s_add_u32 m0, s62, 0x10000
    s_add_u32 s66, s64, s51
    buffer_load_dwordx4 v6, s[36:39], s64 offen lds
    s_add_u32 m0, s62, 0x400
    s_add_u32 s64, s64, s52
    buffer_load_dwordx4 v5, s[32:35], s63 offen lds
    s_add_u32 m0, s62, 0x10400
    s_add_u32 s67, s66, s51
    buffer_load_dwordx4 v6, s[36:39], s66 offen lds
    s_add_u32 m0, s62, 0x800
    s_add_u32 s63, s63, 128
    buffer_load_dwordx4 v4, s[32:35], s68 offen lds
    s_add_u32 m0, s62, 0x10800
    s_add_u32 s66, s67, s51
    buffer_load_dwordx4 v6, s[36:39], s67 offen lds
    s_add_u32 m0, s62, 0xc00
    s_lshr_b32 s67, s62, 2
    buffer_load_dwordx4 v5, s[32:35], s68 offen lds
    s_add_u32 m0, s62, 0x10c00
    s_add_u32 s62, s62, 0x4000
    buffer_load_dwordx4 v6, s[36:39], s66 offen lds
    s_and_b32 s62, s62, 0xffff
    s_add_u32 s57, s57, 1
    s_cmp_eq_u32 s57, 8
    s_cselect_b32 s63, s48, s63
    s_cselect_b32 s64, s50, s64
    s_add_u32 m0, s67, 0x20000
    s_add_u32 s59, s65, 0x800
    buffer_load_dwordx4 v7, s[44:47], s65 offen lds
    s_and_b32 s65, s59, 0x3fff
    s_waitcnt vmcnt(9)
    s_barrier
    s_mov_b32 s69, 6
proj_kernel_l1_ll:
    s_mov_b32 m0, s62
    s_add_u32 s68, s63, 0x4000
    buffer_load_dwordx4 v4, s[32:35], s63 offen lds
    s_add_u32 m0, s62, 0x10000
    s_add_u32 s66, s64, s51
    buffer_load_dwordx4 v6, s[36:39], s64 offen lds
    s_add_u32 m0, s62, 0x400
    s_add_u32 s64, s64, s52
    buffer_load_dwordx4 v5, s[32:35], s63 offen lds
    s_add_u32 m0, s62, 0x10400
    s_add_u32 s67, s66, s51
    buffer_load_dwordx4 v6, s[36:39], s66 offen lds
    s_add_u32 m0, s62, 0x800
    s_add_u32 s63, s63, 128
    buffer_load_dwordx4 v4, s[32:35], s68 offen lds
    s_add_u32 m0, s62, 0x10800
    s_add_u32 s66, s67, s51
    buffer_load_dwordx4 v6, s[36:39], s67 offen lds
    s_add_u32 m0, s62, 0xc00
    s_lshr_b32 s67, s62, 2
    buffer_load_dwordx4 v5, s[32:35], s68 offen lds
    s_add_u32 m0, s62, 0x10c00
    s_add_u32 s62, s62, 0x4000
    buffer_load_dwordx4 v6, s[36:39], s66 offen lds
    s_and_b32 s62, s62, 0xffff
    s_add_u32 s57, s57, 1
    s_cmp_eq_u32 s57, 8
    s_cselect_b32 s63, s48, s63
    s_cselect_b32 s64, s50, s64
    s_add_u32 m0, s67, 0x20000
    s_add_u32 s59, s65, 0x800
    buffer_load_dwordx4 v7, s[44:47], s65 offen lds
    s_and_b32 s65, s59, 0x3fff
    s_waitcnt vmcnt(9)
    s_barrier
    s_sub_u32 s69, s69, 1
    s_cmp_lg_u32 s69, 0
    s_cbranch_scc1 proj_kernel_l1_ll
    s_waitcnt vmcnt(0)
    s_barrier
    s_endpgm
proj_kernel_comp:
    v_and_b32 v1, 31, v0
    v_lshrrev_b32 v2, 5, v0
    v_bfe_u32 v3, v0, 1, 3
    v_xor_b32 v3, v3, v2
    v_lshlrev_b32 v3, 4, v3
    v_lshl_add_u32 v3, v1, 7, v3
    s_lshl_b32 s57, s56, 13
    v_add_u32 v8, s57, v3
    v_xor_b32 v9, 32, v8
    v_xor_b32 v10, 64, v8
    v_xor_b32 v11, 0x60, v8
    v_bfe_u32 v1, v0, 2, 2
    v_bfe_u32 v3, v0, 4, 1
    v_bfe_u32 v12, v0, 1, 1
    v_lshl_add_u32 v3, v3, 1, v12
    s_lshl_b32 s59, s58, 3
    v_add_u32 v3, s59, v3
    v_lshlrev_b32 v12, 2, v1
    v_xor_b32 v3, v3, v12
    v_lshl_add_u32 v1, v2, 3, v1
    v_lshlrev_b32 v1, 8, v1
    v_lshl_add_u32 v1, v3, 4, v1
    v_and_b32 v3, 1, v0
    v_lshl_add_u32 v1, v3, 3, v1
    v_add_u32 v12, 0x10000, v1
    v_xor_b32 v13, 64, v12
    s_cmp_lg_u32 s2, 7
    s_cbranch_scc1 proj_kernel_notab
    v_and_b32 v20, 31, v0
    v_lshrrev_b32 v21, 5, v0
    v_lshlrev_b32 v21, 3, v21
    v_sub_u32 v20, v20, v21
    s_lshr_b32 s72, s19, 1
    s_lshl_b32 s72, s72, 4
    s_and_b32 s73, s19, 1
    s_lshl_b32 s73, s73, 2
    s_add_u32 s72, s72, s73
    v_subrev_u32 v20, s72, v20
    v_mov_b32 v22, 0xff800000
    v_mov_b32 v23, 0
    v_cmp_le_i32 s[74:75], 0, v20
    s_nop 1
    v_cndmask_b32 v24, v22, v23, s[74:75]
    v_cndmask_b32 v28, v23, v22, s[74:75]
    v_cmp_le_i32 s[74:75], 1, v20
    s_nop 1
    v_cndmask_b32 v25, v22, v23, s[74:75]
    v_cndmask_b32 v29, v23, v22, s[74:75]
    v_cmp_le_i32 s[74:75], 2, v20
    s_nop 1
    v_cndmask_b32 v26, v22, v23, s[74:75]
    v_cndmask_b32 v30, v23, v22, s[74:75]
    v_cmp_le_i32 s[74:75], 3, v20
    s_nop 1
    v_cndmask_b32 v27, v22, v23, s[74:75]
    v_cndmask_b32 v31, v23, v22, s[74:75]
    v_lshlrev_b32 v21, 4, v0
    s_lshl_b32 s72, s19, 10
    s_add_u32 s72, s72, 0x820000
    s_add_u32 s73, s72, 0x1000
    buffer_store_dwordx4 v[24:27], v21, s[40:43], s72 offen
    buffer_store_dwordx4 v[28:31], v21, s[40:43], s73 offen
    v_and_b32 v20, 31, v0
    v_cmp_eq_u32 s[74:75], 0, v20
    v_mov_b32 v22, 0x3f803f80
    s_mov_b32 s72, 0x822000
    v_cndmask_b32 v24, v23, v22, s[74:75]
    v_cndmask_b32 v25, v23, v22, s[74:75]
    v_cndmask_b32 v26, v23, v22, s[74:75]
    v_cndmask_b32 v27, v23, v22, s[74:75]
    buffer_store_dwordx4 v[24:27], v21, s[40:43], s72 offen
    v_mov_b64 v[28:29], 0
    v_mov_b64 v[30:31], 0
    s_lshl_b32 s72, s19, 11
    s_add_u32 s72, s72, 0x824000
    buffer_store_dwordx4 v[28:31], v21, s[40:43], s72 offen
    buffer_store_dwordx4 v[28:31], v21, s[40:43], s72 offen offset:1024
    s_waitcnt vmcnt(0)
proj_kernel_notab:
    v_mov_b64 v[48:49], 0
    v_mov_b64 v[50:51], 0
    v_mov_b64 v[52:53], 0
    v_mov_b64 v[54:55], 0
    v_mov_b64 v[56:57], 0
    v_mov_b64 v[58:59], 0
    v_mov_b64 v[60:61], 0
    v_mov_b64 v[62:63], 0
    v_mov_b64 v[64:65], 0
    v_mov_b64 v[66:67], 0
    v_mov_b64 v[68:69], 0
    v_mov_b64 v[70:71], 0
    v_mov_b64 v[72:73], 0
    v_mov_b64 v[74:75], 0
    v_mov_b64 v[76:77], 0
    v_mov_b64 v[78:79], 0
    v_mov_b64 v[80:81], 0
    v_mov_b64 v[82:83], 0
    v_mov_b64 v[84:85], 0
    v_mov_b64 v[86:87], 0
    v_mov_b64 v[88:89], 0
    v_mov_b64 v[90:91], 0
    v_mov_b64 v[92:93], 0
    v_mov_b64 v[94:95], 0
    v_mov_b64 v[96:97], 0
    v_mov_b64 v[98:99], 0
    v_mov_b64 v[100:101], 0
    v_mov_b64 v[102:103], 0
    v_mov_b64 v[104:105], 0
    v_mov_b64 v[106:107], 0
    v_mov_b64 v[108:109], 0
    v_mov_b64 v[110:111], 0
    v_mov_b64 v[112:113], 0
    v_mov_b64 v[114:115], 0
    v_mov_b64 v[116:117], 0
    v_mov_b64 v[118:119], 0
    v_mov_b64 v[120:121], 0
    v_mov_b64 v[122:123], 0
    v_mov_b64 v[124:125], 0
    v_mov_b64 v[126:127], 0
    v_mov_b32 v20, v8
    v_mov_b32 v21, v9
    v_mov_b32 v22, v10
    v_mov_b32 v23, v11
    v_mov_b32 v24, v12
    v_mov_b32 v25, v13
    s_cmp_eq_u32 s22, 3
    s_cbranch_scc1 proj_kernel_v
    s_cmp_eq_u32 s22, 2
    s_cselect_b32 s74, 1.0, 0x3eb8aa3b
    s_lshl_b32 s63, s22, 21
    s_lshl_b32 s64, s21, 3
    s_lshl_b32 s65, s58, 2
    s_add_u32 s64, s64, s65
    s_lshl_b32 s64, s64, 16
    s_add_u32 s63, s63, s64
    s_lshl_b32 s64, s20, 2
    s_lshl_b32 s65, s56, 1
    s_add_u32 s64, s64, s65
    s_lshl_b32 s64, s64, 10
    s_add_u32 s63, s63, s64
    v_lshlrev_b32 v3, 4, v0
    s_cmp_eq_u32 s22, 2
    s_cbranch_scc0 proj_kernel_ep1b
    v_and_b32 v3, 0x33, v0
    v_bfe_u32 v17, v0, 2, 1
    v_lshl_add_u32 v3, v17, 3, v3
    v_bfe_u32 v17, v0, 3, 1
    v_lshl_add_u32 v3, v17, 2, v3
    v_lshlrev_b32 v3, 4, v3
proj_kernel_ep1b:
    s_mov_b32 s75, s74
    s_cmp_lg_u32 s22, 0
    s_cbranch_scc1 proj_kernel_qk
    v_mov_b32 v18, v3
    s_lshl_b32 s60, s20, 2
    s_add_u32 s60, s60, s21
    s_lshl_b32 s60, s60, 10
    v_and_b32 v1, 15, v0
    v_lshrrev_b32 v2, 4, v0
    s_cmp_ge_u32 s19, 2
    s_cbranch_scc1 proj_kernel_kvep_v
    v_and_b32 v3, 3, v1
    v_bfe_u32 v17, v1, 2, 1
    v_lshl_add_u32 v3, v17, 3, v3
    v_bfe_u32 v17, v1, 3, 1
    v_lshl_add_u32 v3, v17, 2, v3
    v_and_b32 v17, 1, v2
    v_lshl_add_u32 v3, v17, 5, v3
    v_lshlrev_b32 v3, 4, v3
    v_lshrrev_b32 v17, 1, v2
    v_lshl_add_u32 v3, v17, 3, v3
    s_lshl_b32 s61, s58, 8
    s_add_u32 s60, s60, s61
    s_add_u32 s60, s60, 0x800000
    s_branch proj_kernel_kvep_s
proj_kernel_kvep_v:
    v_and_b32 v17, 1, v2
    v_lshlrev_b32 v3, 4, v1
    v_lshl_add_u32 v3, v17, 8, v3
    v_lshrrev_b32 v17, 1, v2
    v_lshl_add_u32 v3, v17, 3, v3
    s_lshl_b32 s61, s58, 9
    s_add_u32 s60, s60, s61
    s_add_u32 s60, s60, 0x810000
proj_kernel_kvep_s:
    v_mov_b32 v19, v3
    s_mov_b32 s55, s60
    v_and_b32 v1, 15, v0
    v_lshrrev_b32 v3, 4, v0
    v_bfe_u32 v14, v0, 1, 3
    v_xor_b32 v14, v14, v3
    v_lshlrev_b32 v14, 4, v14
    v_lshl_add_u32 v14, v1, 7, v14
    s_lshl_b32 s60, s21, 12
    s_lshl_b32 s61, s58, 11
    s_add_u32 s60, s60, s61
    v_add_u32 v14, s60, v14
    v_xor_b32 v15, 64, v14
    v_bfe_u32 v1, v0, 2, 2
    v_lshl_add_u32 v1, v3, 3, v1
    v_lshlrev_b32 v1, 5, v1
    v_and_b32 v3, 3, v0
    v_lshl_add_u32 v1, v3, 3, v1
    s_lshl_b32 s61, s56, 11
    s_add_u32 s61, s61, 0x20000
    v_add_u32 v16, s61, v1
    v_mov_b32 v26, v14
    v_mov_b32 v27, v15
    v_mov_b32 v28, v16
    v_mov_b64 v[144:145], 0
    v_mov_b64 v[146:147], 0
    v_mov_b32 v3, v18
    s_cmp_ge_u32 s19, 2
    s_cbranch_scc1 proj_kernel_av
proj_kernel_ak:
    s_mov_b32 s69, 8
    s_mov_b32 s71, 0
proj_kernel_ak_loop:
    s_barrier
    v_mfma_f32_32x32x16_bf16 v[64:79], v[56:59], v[48:51], v[64:79]
    ds_read_b128 v[32:35], v20 offset:0
    ds_read_b64_tr_b16 v[40:41], v24 offset:0
    ds_read_b64_tr_b16 v[42:43], v24 offset:1024
    v_mfma_f32_32x32x16_bf16 v[80:95], v[56:59], v[52:55], v[80:95]
    ds_read_b128 v[36:39], v20 offset:4096
    ds_read_b64_tr_b16 v[44:45], v25 offset:0
    ds_read_b64_tr_b16 v[46:47], v25 offset:1024
    v_mfma_f32_32x32x16_bf16 v[96:111], v[60:63], v[48:51], v[96:111]
    ds_read_b128 v[128:131], v26
    ds_read_b64_tr_b16 v[136:137], v28
    ds_read_b64_tr_b16 v[138:139], v28 offset:128
    v_mfma_f32_32x32x16_bf16 v[112:127], v[60:63], v[52:55], v[112:127]
    ds_read_b128 v[132:135], v27
    ds_read_b64_tr_b16 v[140:141], v28 offset:1024
    ds_read_b64_tr_b16 v[142:143], v28 offset:1152
    s_add_u32 s73, s71, 0x4000
    s_and_b32 s73, s73, 0xffff
    s_waitcnt lgkmcnt(9)
    v_mfma_f32_32x32x16_bf16 v[64:79], v[40:43], v[32:35], v[64:79]
    ds_read_b128 v[48:51], v21 offset:0
    ds_read_b64_tr_b16 v[56:57], v24 offset:4096
    ds_read_b64_tr_b16 v[58:59], v24 offset:5120
    s_waitcnt lgkmcnt(11)
    v_mfma_f32_32x32x16_bf16 v[80:95], v[40:43], v[36:39], v[80:95]
    ds_read_b128 v[52:55], v21 offset:4096
    ds_read_b64_tr_b16 v[60:61], v25 offset:4096
    ds_read_b64_tr_b16 v[62:63], v25 offset:5120
    s_waitcnt lgkmcnt(12)
    v_mfma_f32_32x32x16_bf16 v[96:111], v[44:47], v[32:35], v[96:111]
    v_add_u32 v20, s73, v8
    v_mfma_f32_32x32x16_bf16 v[112:127], v[44:47], v[36:39], v[112:127]
    s_lshr_b32 s72, s73, 2
    v_add_u32 v26, s73, v14
    v_add_u32 v27, s73, v15
    s_waitcnt lgkmcnt(3)
    v_mfma_f32_32x32x16_bf16 v[64:79], v[56:59], v[48:51], v[64:79]
    ds_read_b128 v[32:35], v22 offset:0
    ds_read_b64_tr_b16 v[40:41], v24 offset:8192
    ds_read_b64_tr_b16 v[42:43], v24 offset:9216
    s_waitcnt lgkmcnt(5)
    v_mfma_f32_32x32x16_bf16 v[80:95], v[56:59], v[52:55], v[80:95]
    ds_read_b128 v[36:39], v22 offset:4096
    ds_read_b64_tr_b16 v[44:45], v25 offset:8192
    ds_read_b64_tr_b16 v[46:47], v25 offset:9216
    s_waitcnt lgkmcnt(6)
    v_mfma_f32_32x32x16_bf16 v[96:111], v[60:63], v[48:51], v[96:111]
    v_mfma_f32_16x16x32_bf16 v[144:147], v[136:139], v[128:131], v[144:147]
    v_add_u32 v21, s73, v9
    v_mfma_f32_32x32x16_bf16 v[112:127], v[60:63], v[52:55], v[112:127]
    v_add_u32 v28, s72, v16
    s_waitcnt lgkmcnt(3)
    v_mfma_f32_32x32x16_bf16 v[64:79], v[40:43], v[32:35], v[64:79]
    ds_read_b128 v[48:51], v23 offset:0
    ds_read_b64_tr_b16 v[56:57], v24 offset:12288
    ds_read_b64_tr_b16 v[58:59], v24 offset:13312
    s_waitcnt lgkmcnt(5)
    v_mfma_f32_32x32x16_bf16 v[80:95], v[40:43], v[36:39], v[80:95]
    ds_read_b128 v[52:55], v23 offset:4096
    ds_read_b64_tr_b16 v[60:61], v25 offset:12288
    ds_read_b64_tr_b16 v[62:63], v25 offset:13312
    s_waitcnt lgkmcnt(6)
    v_mfma_f32_32x32x16_bf16 v[96:111], v[44:47], v[32:35], v[96:111]
    v_mfma_f32_16x16x32_bf16 v[144:147], v[140:143], v[132:135], v[144:147]
    s_add_u32 s71, s71, 0x4000
    s_and_b32 s71, s71, 0xffff
    s_sub_u32 s69, s69, 1
    v_add_u32 v22, s73, v10
    v_mfma_f32_32x32x16_bf16 v[112:127], v[44:47], v[36:39], v[112:127]
    v_add_u32 v23, s73, v11
    v_add_u32 v24, s73, v12
    v_add_u32 v25, s73, v13
    s_cmp_lg_u32 s69, 0
    s_waitcnt lgkmcnt(0)
    s_cbranch_scc1 proj_kernel_ak_loop
    v_mfma_f32_32x32x16_bf16 v[64:79], v[56:59], v[48:51], v[64:79]
    v_mfma_f32_32x32x16_bf16 v[80:95], v[56:59], v[52:55], v[80:95]
    v_mfma_f32_32x32x16_bf16 v[96:111], v[60:63], v[48:51], v[96:111]
    v_mfma_f32_32x32x16_bf16 v[112:127], v[60:63], v[52:55], v[112:127]
    s_branch proj_kernel_kvst
proj_kernel_av:
    s_mov_b32 s69, 8
    s_mov_b32 s71, 0
proj_kernel_av_loop:
    s_barrier
    v_mfma_f32_32x32x16_bf16 v[64:79], v[56:59], v[48:51], v[64:79]
    ds_read_b128 v[32:35], v20 offset:0
    ds_read_b64_tr_b16 v[40:41], v24 offset:0
    ds_read_b64_tr_b16 v[42:43], v24 offset:1024
    v_mfma_f32_32x32x16_bf16 v[80:95], v[56:59], v[52:55], v[80:95]
    ds_read_b128 v[36:39], v20 offset:4096
    ds_read_b64_tr_b16 v[44:45], v25 offset:0
    ds_read_b64_tr_b16 v[46:47], v25 offset:1024
    v_mfma_f32_32x32x16_bf16 v[96:111], v[60:63], v[48:51], v[96:111]
    ds_read_b128 v[128:131], v26
    ds_read_b64_tr_b16 v[136:137], v28
    ds_read_b64_tr_b16 v[138:139], v28 offset:128
    v_mfma_f32_32x32x16_bf16 v[112:127], v[60:63], v[52:55], v[112:127]
    ds_read_b128 v[132:135], v27
    ds_read_b64_tr_b16 v[140:141], v28 offset:1024
    ds_read_b64_tr_b16 v[142:143], v28 offset:1152
    s_add_u32 s73, s71, 0x4000
    s_and_b32 s73, s73, 0xffff
    s_waitcnt lgkmcnt(9)
    v_mfma_f32_32x32x16_bf16 v[64:79], v[40:43], v[32:35], v[64:79]
    ds_read_b128 v[48:51], v21 offset:0
    ds_read_b64_tr_b16 v[56:57], v24 offset:4096
    ds_read_b64_tr_b16 v[58:59], v24 offset:5120
    s_waitcnt lgkmcnt(11)
    v_mfma_f32_32x32x16_bf16 v[80:95], v[40:43], v[36:39], v[80:95]
    ds_read_b128 v[52:55], v21 offset:4096
    ds_read_b64_tr_b16 v[60:61], v25 offset:4096
    ds_read_b64_tr_b16 v[62:63], v25 offset:5120
    s_waitcnt lgkmcnt(12)
    v_mfma_f32_32x32x16_bf16 v[96:111], v[44:47], v[32:35], v[96:111]
    v_add_u32 v20, s73, v8
    v_mfma_f32_32x32x16_bf16 v[112:127], v[44:47], v[36:39], v[112:127]
    s_lshr_b32 s72, s73, 2
    v_add_u32 v26, s73, v14
    v_add_u32 v27, s73, v15
    s_waitcnt lgkmcnt(3)
    v_mfma_f32_32x32x16_bf16 v[64:79], v[56:59], v[48:51], v[64:79]
    ds_read_b128 v[32:35], v22 offset:0
    ds_read_b64_tr_b16 v[40:41], v24 offset:8192
    ds_read_b64_tr_b16 v[42:43], v24 offset:9216
    s_waitcnt lgkmcnt(5)
    v_mfma_f32_32x32x16_bf16 v[80:95], v[56:59], v[52:55], v[80:95]
    ds_read_b128 v[36:39], v22 offset:4096
    ds_read_b64_tr_b16 v[44:45], v25 offset:8192
    ds_read_b64_tr_b16 v[46:47], v25 offset:9216
    s_waitcnt lgkmcnt(6)
    v_mfma_f32_32x32x16_bf16 v[96:111], v[60:63], v[48:51], v[96:111]
    v_mfma_f32_16x16x32_bf16 v[144:147], v[128:131], v[136:139], v[144:147]
    v_add_u32 v21, s73, v9
    v_mfma_f32_32x32x16_bf16 v[112:127], v[60:63], v[52:55], v[112:127]
    v_add_u32 v28, s72, v16
    s_waitcnt lgkmcnt(3)
    v_mfma_f32_32x32x16_bf16 v[64:79], v[40:43], v[32:35], v[64:79]
    ds_read_b128 v[48:51], v23 offset:0
    ds_read_b64_tr_b16 v[56:57], v24 offset:12288
    ds_read_b64_tr_b16 v[58:59], v24 offset:13312
    s_waitcnt lgkmcnt(5)
    v_mfma_f32_32x32x16_bf16 v[80:95], v[40:43], v[36:39], v[80:95]
    ds_read_b128 v[52:55], v23 offset:4096
    ds_read_b64_tr_b16 v[60:61], v25 offset:12288
    ds_read_b64_tr_b16 v[62:63], v25 offset:13312
    s_waitcnt lgkmcnt(6)
    v_mfma_f32_32x32x16_bf16 v[96:111], v[44:47], v[32:35], v[96:111]
    v_mfma_f32_16x16x32_bf16 v[144:147], v[132:135], v[140:143], v[144:147]
    s_add_u32 s71, s71, 0x4000
    s_and_b32 s71, s71, 0xffff
    s_sub_u32 s69, s69, 1
    v_add_u32 v22, s73, v10
    v_mfma_f32_32x32x16_bf16 v[112:127], v[44:47], v[36:39], v[112:127]
    v_add_u32 v23, s73, v11
    v_add_u32 v24, s73, v12
    v_add_u32 v25, s73, v13
    s_cmp_lg_u32 s69, 0
    s_waitcnt lgkmcnt(0)
    s_cbranch_scc1 proj_kernel_av_loop
    v_mfma_f32_32x32x16_bf16 v[64:79], v[56:59], v[48:51], v[64:79]
    v_mfma_f32_32x32x16_bf16 v[80:95], v[56:59], v[52:55], v[80:95]
    v_mfma_f32_32x32x16_bf16 v[96:111], v[60:63], v[48:51], v[96:111]
    v_mfma_f32_32x32x16_bf16 v[112:127], v[60:63], v[52:55], v[112:127]
proj_kernel_kvst:
    v_cvt_pk_bf16_f32 v148, v144, v145
    v_cvt_pk_bf16_f32 v149, v146, v147
    buffer_store_dwordx2 v[148:149], v19, s[40:43], s55 offen sc0 sc1
    s_branch proj_kernel_ep1
proj_kernel_qk:
    s_mov_b32 s69, 8
    s_mov_b32 s71, 0
proj_kernel_qk_loop:
    s_barrier
    v_mfma_f32_32x32x16_bf16 v[64:79], v[56:59], v[48:51], v[64:79]
    ds_read_b128 v[32:35], v20 offset:0
    ds_read_b64_tr_b16 v[40:41], v24 offset:0
    ds_read_b64_tr_b16 v[42:43], v24 offset:1024
    v_mfma_f32_32x32x16_bf16 v[80:95], v[56:59], v[52:55], v[80:95]
    ds_read_b128 v[36:39], v20 offset:4096
    ds_read_b64_tr_b16 v[44:45], v25 offset:0
    ds_read_b64_tr_b16 v[46:47], v25 offset:1024
    v_mfma_f32_32x32x16_bf16 v[96:111], v[60:63], v[48:51], v[96:111]
    v_mfma_f32_32x32x16_bf16 v[112:127], v[60:63], v[52:55], v[112:127]
    s_add_u32 s73, s71, 0x4000
    s_and_b32 s73, s73, 0xffff
    s_waitcnt lgkmcnt(3)
    v_mfma_f32_32x32x16_bf16 v[64:79], v[40:43], v[32:35], v[64:79]
    ds_read_b128 v[48:51], v21 offset:0
    ds_read_b64_tr_b16 v[56:57], v24 offset:4096
    ds_read_b64_tr_b16 v[58:59], v24 offset:5120
    s_waitcnt lgkmcnt(5)
    v_mfma_f32_32x32x16_bf16 v[80:95], v[40:43], v[36:39], v[80:95]
    ds_read_b128 v[52:55], v21 offset:4096
    ds_read_b64_tr_b16 v[60:61], v25 offset:4096
    ds_read_b64_tr_b16 v[62:63], v25 offset:5120
    s_waitcnt lgkmcnt(6)
    v_mfma_f32_32x32x16_bf16 v[96:111], v[44:47], v[32:35], v[96:111]
    v_add_u32 v20, s73, v8
    v_mfma_f32_32x32x16_bf16 v[112:127], v[44:47], v[36:39], v[112:127]
    s_waitcnt lgkmcnt(3)
    v_mfma_f32_32x32x16_bf16 v[64:79], v[56:59], v[48:51], v[64:79]
    ds_read_b128 v[32:35], v22 offset:0
    ds_read_b64_tr_b16 v[40:41], v24 offset:8192
    ds_read_b64_tr_b16 v[42:43], v24 offset:9216
    s_waitcnt lgkmcnt(5)
    v_mfma_f32_32x32x16_bf16 v[80:95], v[56:59], v[52:55], v[80:95]
    ds_read_b128 v[36:39], v22 offset:4096
    ds_read_b64_tr_b16 v[44:45], v25 offset:8192
    ds_read_b64_tr_b16 v[46:47], v25 offset:9216
    s_waitcnt lgkmcnt(6)
    v_mfma_f32_32x32x16_bf16 v[96:111], v[60:63], v[48:51], v[96:111]
    v_add_u32 v21, s73, v9
    v_mfma_f32_32x32x16_bf16 v[112:127], v[60:63], v[52:55], v[112:127]
    s_waitcnt lgkmcnt(3)
    v_mfma_f32_32x32x16_bf16 v[64:79], v[40:43], v[32:35], v[64:79]
    ds_read_b128 v[48:51], v23 offset:0
    ds_read_b64_tr_b16 v[56:57], v24 offset:12288
    ds_read_b64_tr_b16 v[58:59], v24 offset:13312
    s_waitcnt lgkmcnt(5)
    v_mfma_f32_32x32x16_bf16 v[80:95], v[40:43], v[36:39], v[80:95]
    ds_read_b128 v[52:55], v23 offset:4096
    ds_read_b64_tr_b16 v[60:61], v25 offset:12288
    ds_read_b64_tr_b16 v[62:63], v25 offset:13312
    s_waitcnt lgkmcnt(6)
    v_mfma_f32_32x32x16_bf16 v[96:111], v[44:47], v[32:35], v[96:111]
    s_add_u32 s71, s71, 0x4000
    s_and_b32 s71, s71, 0xffff
    s_sub_u32 s69, s69, 1
    v_add_u32 v22, s73, v10
    v_mfma_f32_32x32x16_bf16 v[112:127], v[44:47], v[36:39], v[112:127]
    v_add_u32 v23, s73, v11
    v_add_u32 v24, s73, v12
    v_add_u32 v25, s73, v13
    s_cmp_lg_u32 s69, 0
    s_waitcnt lgkmcnt(0)
    s_cbranch_scc1 proj_kernel_qk_loop
    v_mfma_f32_32x32x16_bf16 v[64:79], v[56:59], v[48:51], v[64:79]
    v_mfma_f32_32x32x16_bf16 v[80:95], v[56:59], v[52:55], v[80:95]
    v_mfma_f32_32x32x16_bf16 v[96:111], v[60:63], v[48:51], v[96:111]
    v_mfma_f32_32x32x16_bf16 v[112:127], v[60:63], v[52:55], v[112:127]
    s_nop 1
proj_kernel_ep1:
    v_pk_mul_f32 v[64:65], v[64:65], s[74:75]
    v_pk_mul_f32 v[66:67], v[66:67], s[74:75]
    v_pk_mul_f32 v[68:69], v[68:69], s[74:75]
    v_pk_mul_f32 v[70:71], v[70:71], s[74:75]
    v_cvt_pk_bf16_f32 v32, v64, v65
    v_cvt_pk_bf16_f32 v33, v66, v67
    v_cvt_pk_bf16_f32 v34, v68, v69
    v_cvt_pk_bf16_f32 v35, v70, v71
    s_add_u32 s64, s63, 0x0
    buffer_store_dwordx4 v[32:35], v3, s[40:43], s64 offen sc0 sc1
    v_pk_mul_f32 v[72:73], v[72:73], s[74:75]
    v_pk_mul_f32 v[74:75], v[74:75], s[74:75]
    v_pk_mul_f32 v[76:77], v[76:77], s[74:75]
    v_pk_mul_f32 v[78:79], v[78:79], s[74:75]
    v_cvt_pk_bf16_f32 v36, v72, v73
    v_cvt_pk_bf16_f32 v37, v74, v75
    v_cvt_pk_bf16_f32 v38, v76, v77
    v_cvt_pk_bf16_f32 v39, v78, v79
    s_add_u32 s64, s63, 0x10000
    buffer_store_dwordx4 v[36:39], v3, s[40:43], s64 offen sc0 sc1
    v_pk_mul_f32 v[80:81], v[80:81], s[74:75]
    v_pk_mul_f32 v[82:83], v[82:83], s[74:75]
    v_pk_mul_f32 v[84:85], v[84:85], s[74:75]
    v_pk_mul_f32 v[86:87], v[86:87], s[74:75]
    v_cvt_pk_bf16_f32 v40, v80, v81
    v_cvt_pk_bf16_f32 v41, v82, v83
    v_cvt_pk_bf16_f32 v42, v84, v85
    v_cvt_pk_bf16_f32 v43, v86, v87
    s_add_u32 s64, s63, 0x400
    buffer_store_dwordx4 v[40:43], v3, s[40:43], s64 offen sc0 sc1
    v_pk_mul_f32 v[88:89], v[88:89], s[74:75]
    v_pk_mul_f32 v[90:91], v[90:91], s[74:75]
    v_pk_mul_f32 v[92:93], v[92:93], s[74:75]
    v_pk_mul_f32 v[94:95], v[94:95], s[74:75]
    v_cvt_pk_bf16_f32 v44, v88, v89
    v_cvt_pk_bf16_f32 v45, v90, v91
    v_cvt_pk_bf16_f32 v46, v92, v93
    v_cvt_pk_bf16_f32 v47, v94, v95
    s_add_u32 s64, s63, 0x10400
    buffer_store_dwordx4 v[44:47], v3, s[40:43], s64 offen sc0 sc1
    v_pk_mul_f32 v[96:97], v[96:97], s[74:75]
    v_pk_mul_f32 v[98:99], v[98:99], s[74:75]
    v_pk_mul_f32 v[100:101], v[100:101], s[74:75]
    v_pk_mul_f32 v[102:103], v[102:103], s[74:75]
    v_cvt_pk_bf16_f32 v32, v96, v97
    v_cvt_pk_bf16_f32 v33, v98, v99
    v_cvt_pk_bf16_f32 v34, v100, v101
    v_cvt_pk_bf16_f32 v35, v102, v103
    s_add_u32 s64, s63, 0x20000
    buffer_store_dwordx4 v[32:35], v3, s[40:43], s64 offen sc0 sc1
    v_pk_mul_f32 v[104:105], v[104:105], s[74:75]
    v_pk_mul_f32 v[106:107], v[106:107], s[74:75]
    v_pk_mul_f32 v[108:109], v[108:109], s[74:75]
    v_pk_mul_f32 v[110:111], v[110:111], s[74:75]
    v_cvt_pk_bf16_f32 v36, v104, v105
    v_cvt_pk_bf16_f32 v37, v106, v107
    v_cvt_pk_bf16_f32 v38, v108, v109
    v_cvt_pk_bf16_f32 v39, v110, v111
    s_add_u32 s64, s63, 0x30000
    buffer_store_dwordx4 v[36:39], v3, s[40:43], s64 offen sc0 sc1
    v_pk_mul_f32 v[112:113], v[112:113], s[74:75]
    v_pk_mul_f32 v[114:115], v[114:115], s[74:75]
    v_pk_mul_f32 v[116:117], v[116:117], s[74:75]
    v_pk_mul_f32 v[118:119], v[118:119], s[74:75]
    v_cvt_pk_bf16_f32 v40, v112, v113
    v_cvt_pk_bf16_f32 v41, v114, v115
    v_cvt_pk_bf16_f32 v42, v116, v117
    v_cvt_pk_bf16_f32 v43, v118, v119
    s_add_u32 s64, s63, 0x20400
    buffer_store_dwordx4 v[40:43], v3, s[40:43], s64 offen sc0 sc1
    v_pk_mul_f32 v[120:121], v[120:121], s[74:75]
    v_pk_mul_f32 v[122:123], v[122:123], s[74:75]
    v_pk_mul_f32 v[124:125], v[124:125], s[74:75]
    v_pk_mul_f32 v[126:127], v[126:127], s[74:75]
    v_cvt_pk_bf16_f32 v44, v120, v121
    v_cvt_pk_bf16_f32 v45, v122, v123
    v_cvt_pk_bf16_f32 v46, v124, v125
    v_cvt_pk_bf16_f32 v47, v126, v127
    s_add_u32 s64, s63, 0x30400
    buffer_store_dwordx4 v[44:47], v3, s[40:43], s64 offen sc0 sc1
    s_endpgm
proj_kernel_v:
    s_lshl_b32 s64, s21, 3
    s_lshl_b32 s65, s58, 2
    s_add_u32 s64, s64, s65
    s_lshl_b32 s63, s64, 16
    s_lshl_b32 s64, s20, 2
    s_lshl_b32 s65, s56, 1
    s_add_u32 s64, s64, s65
    s_lshl_b32 s64, s64, 10
    s_add_u32 s63, s63, s64
    s_add_u32 s63, s63, 0x600000
    v_and_b32 v3, 15, v0
    v_lshlrev_b32 v3, 4, v3
    v_bfe_u32 v17, v0, 4, 1
    v_lshl_add_u32 v3, v17, 16, v3
    v_lshrrev_b32 v17, 5, v0
    v_lshl_add_u32 v3, v17, 8, v3
proj_kernel_vv:
    s_mov_b32 s69, 8
    s_mov_b32 s71, 0
proj_kernel_vv_loop:
    s_barrier
    v_mfma_f32_32x32x16_bf16 v[64:79], v[48:51], v[56:59], v[64:79]
    ds_read_b128 v[32:35], v20 offset:0
    ds_read_b64_tr_b16 v[40:41], v24 offset:0
    ds_read_b64_tr_b16 v[42:43], v24 offset:1024
    v_mfma_f32_32x32x16_bf16 v[80:95], v[52:55], v[56:59], v[80:95]
    ds_read_b128 v[36:39], v20 offset:4096
    ds_read_b64_tr_b16 v[44:45], v25 offset:0
    ds_read_b64_tr_b16 v[46:47], v25 offset:1024
    v_mfma_f32_32x32x16_bf16 v[96:111], v[48:51], v[60:63], v[96:111]
    v_mfma_f32_32x32x16_bf16 v[112:127], v[52:55], v[60:63], v[112:127]
    s_add_u32 s73, s71, 0x4000
    s_and_b32 s73, s73, 0xffff
    s_waitcnt lgkmcnt(3)
    v_mfma_f32_32x32x16_bf16 v[64:79], v[32:35], v[40:43], v[64:79]
    ds_read_b128 v[48:51], v21 offset:0
    ds_read_b64_tr_b16 v[56:57], v24 offset:4096
    ds_read_b64_tr_b16 v[58:59], v24 offset:5120
    s_waitcnt lgkmcnt(5)
    v_mfma_f32_32x32x16_bf16 v[80:95], v[36:39], v[40:43], v[80:95]
    ds_read_b128 v[52:55], v21 offset:4096
    ds_read_b64_tr_b16 v[60:61], v25 offset:4096
    ds_read_b64_tr_b16 v[62:63], v25 offset:5120
    s_waitcnt lgkmcnt(6)
    v_mfma_f32_32x32x16_bf16 v[96:111], v[32:35], v[44:47], v[96:111]
    v_add_u32 v20, s73, v8
    v_mfma_f32_32x32x16_bf16 v[112:127], v[36:39], v[44:47], v[112:127]
    s_waitcnt lgkmcnt(3)
    v_mfma_f32_32x32x16_bf16 v[64:79], v[48:51], v[56:59], v[64:79]
    ds_read_b128 v[32:35], v22 offset:0
    ds_read_b64_tr_b16 v[40:41], v24 offset:8192
    ds_read_b64_tr_b16 v[42:43], v24 offset:9216
    s_waitcnt lgkmcnt(5)
    v_mfma_f32_32x32x16_bf16 v[80:95], v[52:55], v[56:59], v[80:95]
    ds_read_b128 v[36:39], v22 offset:4096
    ds_read_b64_tr_b16 v[44:45], v25 offset:8192
    ds_read_b64_tr_b16 v[46:47], v25 offset:9216
    s_waitcnt lgkmcnt(6)
    v_mfma_f32_32x32x16_bf16 v[96:111], v[48:51], v[60:63], v[96:111]
    v_add_u32 v21, s73, v9
    v_mfma_f32_32x32x16_bf16 v[112:127], v[52:55], v[60:63], v[112:127]
    s_waitcnt lgkmcnt(3)
    v_mfma_f32_32x32x16_bf16 v[64:79], v[32:35], v[40:43], v[64:79]
    ds_read_b128 v[48:51], v23 offset:0
    ds_read_b64_tr_b16 v[56:57], v24 offset:12288
    ds_read_b64_tr_b16 v[58:59], v24 offset:13312
    s_waitcnt lgkmcnt(5)
    v_mfma_f32_32x32x16_bf16 v[80:95], v[36:39], v[40:43], v[80:95]
    ds_read_b128 v[52:55], v23 offset:4096
    ds_read_b64_tr_b16 v[60:61], v25 offset:12288
    ds_read_b64_tr_b16 v[62:63], v25 offset:13312
    s_waitcnt lgkmcnt(6)
    v_mfma_f32_32x32x16_bf16 v[96:111], v[32:35], v[44:47], v[96:111]
    s_add_u32 s71, s71, 0x4000
    s_and_b32 s71, s71, 0xffff
    s_sub_u32 s69, s69, 1
    v_add_u32 v22, s73, v10
    v_mfma_f32_32x32x16_bf16 v[112:127], v[36:39], v[44:47], v[112:127]
    v_add_u32 v23, s73, v11
    v_add_u32 v24, s73, v12
    v_add_u32 v25, s73, v13
    s_cmp_lg_u32 s69, 0
    s_waitcnt lgkmcnt(0)
    s_cbranch_scc1 proj_kernel_vv_loop
    v_mfma_f32_32x32x16_bf16 v[64:79], v[48:51], v[56:59], v[64:79]
    v_mfma_f32_32x32x16_bf16 v[80:95], v[52:55], v[56:59], v[80:95]
    v_mfma_f32_32x32x16_bf16 v[96:111], v[48:51], v[60:63], v[96:111]
    v_mfma_f32_32x32x16_bf16 v[112:127], v[52:55], v[60:63], v[112:127]
    s_nop 1
    v_cvt_pk_bf16_f32 v32, v64, v65
    v_cvt_pk_bf16_f32 v33, v66, v67
    v_cvt_pk_bf16_f32 v34, v68, v69
    v_cvt_pk_bf16_f32 v35, v70, v71
    s_add_u32 s64, s63, 0x0
    buffer_store_dwordx4 v[32:35], v3, s[40:43], s64 offen sc0 sc1
    v_cvt_pk_bf16_f32 v36, v72, v73
    v_cvt_pk_bf16_f32 v37, v74, v75
    v_cvt_pk_bf16_f32 v38, v76, v77
    v_cvt_pk_bf16_f32 v39, v78, v79
    s_add_u32 s64, s63, 0x200
    buffer_store_dwordx4 v[36:39], v3, s[40:43], s64 offen sc0 sc1
    v_cvt_pk_bf16_f32 v40, v80, v81
    v_cvt_pk_bf16_f32 v41, v82, v83
    v_cvt_pk_bf16_f32 v42, v84, v85
    v_cvt_pk_bf16_f32 v43, v86, v87
    s_add_u32 s64, s63, 0x400
    buffer_store_dwordx4 v[40:43], v3, s[40:43], s64 offen sc0 sc1
    v_cvt_pk_bf16_f32 v44, v88, v89
    v_cvt_pk_bf16_f32 v45, v90, v91
    v_cvt_pk_bf16_f32 v46, v92, v93
    v_cvt_pk_bf16_f32 v47, v94, v95
    s_add_u32 s64, s63, 0x600
    buffer_store_dwordx4 v[44:47], v3, s[40:43], s64 offen sc0 sc1
    v_cvt_pk_bf16_f32 v32, v96, v97
    v_cvt_pk_bf16_f32 v33, v98, v99
    v_cvt_pk_bf16_f32 v34, v100, v101
    v_cvt_pk_bf16_f32 v35, v102, v103
    s_add_u32 s64, s63, 0x20000
    buffer_store_dwordx4 v[32:35], v3, s[40:43], s64 offen sc0 sc1
    v_cvt_pk_bf16_f32 v36, v104, v105
    v_cvt_pk_bf16_f32 v37, v106, v107
    v_cvt_pk_bf16_f32 v38, v108, v109
    v_cvt_pk_bf16_f32 v39, v110, v111
    s_add_u32 s64, s63, 0x20200
    buffer_store_dwordx4 v[36:39], v3, s[40:43], s64 offen sc0 sc1
    v_cvt_pk_bf16_f32 v40, v112, v113
    v_cvt_pk_bf16_f32 v41, v114, v115
    v_cvt_pk_bf16_f32 v42, v116, v117
    v_cvt_pk_bf16_f32 v43, v118, v119
    s_add_u32 s64, s63, 0x20400
    buffer_store_dwordx4 v[40:43], v3, s[40:43], s64 offen sc0 sc1
    v_cvt_pk_bf16_f32 v44, v120, v121
    v_cvt_pk_bf16_f32 v45, v122, v123
    v_cvt_pk_bf16_f32 v46, v124, v125
    v_cvt_pk_bf16_f32 v47, v126, v127
    s_add_u32 s64, s63, 0x20600
    buffer_store_dwordx4 v[44:47], v3, s[40:43], s64 offen sc0 sc1
proj_kernel_end:
    s_endpgm
.globl attn_kernel
.p2align 8
.type attn_kernel,@function
attn_kernel:
    s_cmp_ge_u32 s2, 256
    s_cbranch_scc1 attn_kernel_end
    s_load_dwordx2 s[4:5], s[0:1], 80
    s_load_dwordx2 s[46:47], s[0:1], 32
    s_load_dwordx4 s[48:51], s[0:1], 56
    v_lshrrev_b32 v1, 6, v0
    v_and_b32 v0, 63, v0
    s_bfe_u32 s6, s2, 0x20003
    v_readfirstlane_b32 s7, v1
    s_and_b32 s8, s2, 7
    s_lshl_b32 s8, s8, 3
    s_lshr_b32 s9, s2, 5
    s_add_u32 s8, s8, s9
    s_lshl_b32 s6, s6, 3
    s_add_u32 s6, s6, s7
    v_lshlrev_b32 v2, 4, v0
    v_and_b32 v3, 15, v0
    v_lshlrev_b32 v3, 4, v3
    v_lshrrev_b32 v1, 5, v0
    v_lshl_add_u32 v3, v1, 8, v3
    s_mov_b32 s16, 0x0000ffff
    s_mov_b32 s17, 0x0000ffff
    s_lshl_b32 s10, s6, 16
    s_lshl_b32 s11, s8, 10
    s_add_u32 s10, s10, s11
    s_waitcnt lgkmcnt(0)
    s_mov_b32 s12, s4
    s_and_b32 s13, s5, 0xffff
    s_mov_b32 s14, 0xd00000
    s_mov_b32 s15, 0x20000
    buffer_load_dwordx4 v[84:87], v2, s[12:15], s10 offen
    s_mov_b32 s22, 0x800000
    buffer_load_dwordx4 v[88:91], v2, s[12:15], s22 offen
    s_lshl_b32 s21, s7, 10
    s_add_u32 s22, s21, 0x800000
    s_add_u32 m0, s21, 0
    s_add_u32 s23, s22, 0
    buffer_load_dwordx4 v2, s[12:15], s23 offen lds
    s_add_u32 m0, s21, 65536
    s_add_u32 s23, s22, 65536
    buffer_load_dwordx4 v2, s[12:15], s23 offen lds
    s_add_u32 m0, s21, 8192
    s_add_u32 s23, s22, 8192
    buffer_load_dwordx4 v2, s[12:15], s23 offen lds
    s_add_u32 m0, s21, 73728
    s_add_u32 s23, s22, 73728
    buffer_load_dwordx4 v2, s[12:15], s23 offen lds
    s_setprio 1
    s_cmp_ge_u32 s7, 4
    s_cbranch_scc1 attn_kernel_np
    s_setprio 2
attn_kernel_np:
    s_add_u32 s19, s10, 0x400000
    s_sub_u32 s20, s19, s11
    v_mov_b32 v12, 0xdddddddd
    v_mov_b64 v[104:105], 0
    v_mov_b64 v[106:107], 0
    v_mov_b64 v[108:109], 0
    v_mov_b64 v[110:111], 0
    v_mov_b32 v8, 0x3f803f80
    v_mov_b32 v9, v8
    v_mov_b32 v10, v8
    v_mov_b32 v11, v8
    s_mul_i32 s24, s7, 1280
    s_add_u32 s24, s24, 0x20000
    v_add_u32 v6, s24, v2
    ds_write_b128 v6, v[8:11]
    ds_write_b128 v6, v[104:107] offset:10240
    s_mov_b64 exec, 0xffff
    ds_write_b128 v6, v[8:11] offset:1024
    ds_write_b128 v6, v[104:107] offset:11264
    s_mov_b64 exec, -1
    v_add_u32 v5, 0x10000, v3
    v_mov_b32 v15, 8192
    v_mov_b32 v4, v3
    v_mov_b32 v6, -1
    s_not_b64 exec, s[16:17]
    v_and_b32 v5, 0xff, v3
    v_add_u32 v5, 141312, v5
    v_mov_b32 v15, 0
    v_mov_b32 v6, 0
    v_mov_b32 v4, 0x822010
    s_mov_b32 exec_lo, 0x00110000
    s_mov_b32 exec_hi, 0x00110000
    v_subrev_u32 v5, 10240, v5
    v_mov_b32 v4, 0x822000
    s_mov_b64 exec, -1
    s_min_u32 s28, s8, 8
    v_mov_b64 v[32:33], 0
    v_mov_b64 v[34:35], 0
    v_mov_b64 v[36:37], 0
    v_mov_b64 v[38:39], 0
    v_mov_b64 v[40:41], 0
    v_mov_b64 v[42:43], 0
    v_mov_b64 v[44:45], 0
    v_mov_b64 v[46:47], 0
    v_mov_b64 v[64:65], 0
    v_mov_b64 v[66:67], 0
    v_mov_b64 v[68:69], 0
    v_mov_b64 v[70:71], 0
    v_mov_b64 v[72:73], 0
    v_mov_b64 v[74:75], 0
    v_mov_b64 v[76:77], 0
    v_mov_b64 v[78:79], 0
    s_mov_b32 s29, 0
    s_mov_b32 s35, 1
    s_cmp_lt_u32 s7, 4
    s_cbranch_scc1 attn_kernel_lead
    s_waitcnt vmcnt(0) lgkmcnt(0)
    s_barrier
    s_lshl_b32 s21, s7, 11
    s_add_u32 s21, s21, 8192
    s_add_u32 s22, s21, 0x800000
    s_add_u32 m0, s21, 0
    s_add_u32 s23, s22, 0
    buffer_load_dwordx4 v2, s[12:15], s23 offen lds
    buffer_load_dwordx4 v2, s[12:15], s23 offen offset:1024 lds
    s_add_u32 m0, s21, 65536
    s_add_u32 s23, s22, 65536
    buffer_load_dwordx4 v2, s[12:15], s23 offen lds
    buffer_load_dwordx4 v2, s[12:15], s23 offen offset:1024 lds
    s_add_u32 m0, s21, 8192
    s_add_u32 s23, s22, 8192
    buffer_load_dwordx4 v2, s[12:15], s23 offen lds
    buffer_load_dwordx4 v2, s[12:15], s23 offen offset:1024 lds
    s_add_u32 m0, s21, 73728
    s_add_u32 s23, s22, 73728
    buffer_load_dwordx4 v2, s[12:15], s23 offen lds
    buffer_load_dwordx4 v2, s[12:15], s23 offen offset:1024 lds
    s_add_u32 m0, s21, 16384
    s_add_u32 s23, s22, 16384
    buffer_load_dwordx4 v2, s[12:15], s23 offen lds
    buffer_load_dwordx4 v2, s[12:15], s23 offen offset:1024 lds
    s_add_u32 m0, s21, 81920
    s_add_u32 s23, s22, 81920
    buffer_load_dwordx4 v2, s[12:15], s23 offen lds
    buffer_load_dwordx4 v2, s[12:15], s23 offen offset:1024 lds
    s_add_u32 m0, s21, 24576
    s_add_u32 s23, s22, 24576
    buffer_load_dwordx4 v2, s[12:15], s23 offen lds
    buffer_load_dwordx4 v2, s[12:15], s23 offen offset:1024 lds
    s_add_u32 m0, s21, 90112
    s_add_u32 s23, s22, 90112
    buffer_load_dwordx4 v2, s[12:15], s23 offen lds
    buffer_load_dwordx4 v2, s[12:15], s23 offen offset:1024 lds
attn_kernel_lead:
    s_cbranch_scc0 attn_kernel_l2
    s_waitcnt vmcnt(4)
attn_kernel_l2:
    v_mfma_f32_32x32x16_bf16 v[16:31], v[88:91], v[84:87], v[32:47]
    s_nop 11
    v_max3_f32 v8, v16, v17, v18
    v_max3_f32 v9, v19, v20, v21
    v_max3_f32 v8, v8, v22, v23
    v_max3_f32 v9, v9, v24, v25
    v_max3_f32 v8, v8, v26, v27
    v_max3_f32 v9, v9, v28, v29
    v_max3_f32 v8, v8, v30, v31
    v_max_f32 v10, v8, v9
    v_mov_b32 v8, v10
    s_nop 1
    v_permlane32_swap_b32 v8, v10
    s_nop 1
    v_max_f32 v10, v8, v10
    v_add_f32 v10, 0x42c80000, v10
attn_kernel_A_go:
    v_sub_f32 v8, 0, v10
    v_sub_f32 v9, 0, v10
    v_mov_b64 v[48:49], v[8:9]
    v_mov_b64 v[50:51], v[8:9]
    v_mov_b64 v[52:53], v[8:9]
    v_mov_b64 v[54:55], v[8:9]
    v_mov_b64 v[56:57], v[8:9]
    v_mov_b64 v[58:59], v[8:9]
    v_mov_b64 v[60:61], v[8:9]
    v_mov_b64 v[62:63], v[8:9]
    v_mov_b32 v13, v2
    v_mov_b32 v14, v5
    s_cmp_lg_u32 s29, 0
    s_cbranch_scc1 attn_kernel_A_nb
    s_cmp_lt_u32 s7, 4
    s_cbranch_scc1 attn_kernel_A_b1
    s_waitcnt vmcnt(8)
    s_barrier
    s_add_u32 m0, s21, 32768
    s_add_u32 s23, s22, 32768
    buffer_load_dwordx4 v2, s[12:15], s23 offen lds
    buffer_load_dwordx4 v2, s[12:15], s23 offen offset:1024 lds
    s_add_u32 m0, s21, 98304
    s_add_u32 s23, s22, 98304
    buffer_load_dwordx4 v2, s[12:15], s23 offen lds
    buffer_load_dwordx4 v2, s[12:15], s23 offen offset:1024 lds
    s_add_u32 m0, s21, 40960
    s_add_u32 s23, s22, 40960
    buffer_load_dwordx4 v2, s[12:15], s23 offen lds
    buffer_load_dwordx4 v2, s[12:15], s23 offen offset:1024 lds
    s_add_u32 m0, s21, 106496
    s_add_u32 s23, s22, 106496
    buffer_load_dwordx4 v2, s[12:15], s23 offen lds
    buffer_load_dwordx4 v2, s[12:15], s23 offen offset:1024 lds
    s_branch attn_kernel_A_nb
attn_kernel_A_b1:
    s_waitcnt vmcnt(0) lgkmcnt(0)
    s_barrier
attn_kernel_A_nb:
    ds_read_b128 v[92:95], v13 offset:1024
    ds_read_b128 v[96:99], v14 offset:0
    ds_read_b128 v[100:103], v14 offset:512
    v_mfma_f32_32x32x16_bf16 v[16:31], v[88:91], v[84:87], v[48:63]
    s_mov_b32 s34, 0
    s_nop 12
attn_kernel_A_loop:
    s_cmp_eq_u32 s34, s35
    s_cbranch_scc1 attn_kernel_side
attn_kernel_A_cont:
    v_exp_f32 v16, v16
    v_exp_f32 v17, v17
    v_exp_f32 v18, v18
    v_smfmac_f32_32x32x32_bf16 v[64:79], v[108:111], v[40:47], v12
    ds_read_b128 v[88:91], v13 offset:2048
    s_waitcnt lgkmcnt(1)
    v_exp_f32 v19, v19
    v_exp_f32 v20, v20
    v_exp_f32 v21, v21
    v_exp_f32 v22, v22
    v_mfma_f32_32x32x16_bf16 v[32:47], v[92:95], v[84:87], v[48:63]
    ds_read_b128 v[104:107], v14 offset:1024
    v_exp_f32 v23, v23
    v_exp_f32 v24, v24
    v_exp_f32 v25, v25
    v_exp_f32 v26, v26
    v_smfmac_f32_32x32x32_bf16 v[64:79], v[96:99], v[16:23], v12
    ds_read_b128 v[108:111], v14 offset:1536
    v_exp_f32 v27, v27
    v_exp_f32 v28, v28
    v_exp_f32 v29, v29
    v_exp_f32 v30, v30
    v_exp_f32 v31, v31
    v_exp_f32 v32, v32
    v_exp_f32 v33, v33
    v_exp_f32 v34, v34
    v_smfmac_f32_32x32x32_bf16 v[64:79], v[100:103], v[24:31], v12
    ds_read_b128 v[92:95], v13 offset:3072
    s_waitcnt lgkmcnt(1)
    v_exp_f32 v35, v35
    v_exp_f32 v36, v36
    v_exp_f32 v37, v37
    v_exp_f32 v38, v38
    v_mfma_f32_32x32x16_bf16 v[16:31], v[88:91], v[84:87], v[48:63]
    ds_read_b128 v[96:99], v14 offset:2048
    v_exp_f32 v39, v39
    v_exp_f32 v40, v40
    v_exp_f32 v41, v41
    v_exp_f32 v42, v42
    v_smfmac_f32_32x32x32_bf16 v[64:79], v[104:107], v[32:39], v12
    ds_read_b128 v[100:103], v14 offset:2560
    v_exp_f32 v43, v43
    v_exp_f32 v44, v44
    v_exp_f32 v45, v45
    v_exp_f32 v46, v46
    v_exp_f32 v47, v47
    v_exp_f32 v16, v16
    v_exp_f32 v17, v17
    v_exp_f32 v18, v18
    v_smfmac_f32_32x32x32_bf16 v[64:79], v[108:111], v[40:47], v12
    ds_read_b128 v[88:91], v13 offset:4096
    s_waitcnt lgkmcnt(1)
    v_exp_f32 v19, v19
    v_exp_f32 v20, v20
    v_exp_f32 v21, v21
    v_exp_f32 v22, v22
    v_mfma_f32_32x32x16_bf16 v[32:47], v[92:95], v[84:87], v[48:63]
    ds_read_b128 v[104:107], v14 offset:3072
    v_exp_f32 v23, v23
    v_exp_f32 v24, v24
    v_exp_f32 v25, v25
    v_exp_f32 v26, v26
    v_smfmac_f32_32x32x32_bf16 v[64:79], v[96:99], v[16:23], v12
    ds_read_b128 v[108:111], v14 offset:3584
    v_exp_f32 v27, v27
    v_exp_f32 v28, v28
    v_exp_f32 v29, v29
    v_exp_f32 v30, v30
    v_exp_f32 v31, v31
    v_exp_f32 v32, v32
    v_exp_f32 v33, v33
    v_exp_f32 v34, v34
    v_smfmac_f32_32x32x32_bf16 v[64:79], v[100:103], v[24:31], v12
    ds_read_b128 v[92:95], v13 offset:5120
    s_waitcnt lgkmcnt(1)
    v_exp_f32 v35, v35
    v_exp_f32 v36, v36
    v_exp_f32 v37, v37
    v_exp_f32 v38, v38
    v_mfma_f32_32x32x16_bf16 v[16:31], v[88:91], v[84:87], v[48:63]
    ds_read_b128 v[96:99], v14 offset:4096
    v_exp_f32 v39, v39
    v_exp_f32 v40, v40
    v_exp_f32 v41, v41
    v_exp_f32 v42, v42
    v_smfmac_f32_32x32x32_bf16 v[64:79], v[104:107], v[32:39], v12
    ds_read_b128 v[100:103], v14 offset:4608
    v_exp_f32 v43, v43
    v_exp_f32 v44, v44
    v_exp_f32 v45, v45
    v_exp_f32 v46, v46
    v_exp_f32 v47, v47
    v_exp_f32 v16, v16
    v_exp_f32 v17, v17
    v_exp_f32 v18, v18
    v_smfmac_f32_32x32x32_bf16 v[64:79], v[108:111], v[40:47], v12
    ds_read_b128 v[88:91], v13 offset:6144
    s_waitcnt lgkmcnt(1)
    v_exp_f32 v19, v19
    v_exp_f32 v20, v20
    v_exp_f32 v21, v21
    v_exp_f32 v22, v22
    v_mfma_f32_32x32x16_bf16 v[32:47], v[92:95], v[84:87], v[48:63]
    ds_read_b128 v[104:107], v14 offset:5120
    v_exp_f32 v23, v23
    v_exp_f32 v24, v24
    v_exp_f32 v25, v25
    v_exp_f32 v26, v26
    v_smfmac_f32_32x32x32_bf16 v[64:79], v[96:99], v[16:23], v12
    ds_read_b128 v[108:111], v14 offset:5632
    v_exp_f32 v27, v27
    v_exp_f32 v28, v28
    v_exp_f32 v29, v29
    v_exp_f32 v30, v30
    v_exp_f32 v31, v31
    v_exp_f32 v32, v32
    v_exp_f32 v33, v33
    v_exp_f32 v34, v34
    v_smfmac_f32_32x32x32_bf16 v[64:79], v[100:103], v[24:31], v12
    ds_read_b128 v[92:95], v13 offset:7168
    s_waitcnt lgkmcnt(1)
    v_exp_f32 v35, v35
    v_exp_f32 v36, v36
    v_exp_f32 v37, v37
    v_exp_f32 v38, v38
    v_mfma_f32_32x32x16_bf16 v[16:31], v[88:91], v[84:87], v[48:63]
    ds_read_b128 v[96:99], v14 offset:6144
    v_exp_f32 v39, v39
    v_exp_f32 v40, v40
    v_exp_f32 v41, v41
    v_exp_f32 v42, v42
    v_smfmac_f32_32x32x32_bf16 v[64:79], v[104:107], v[32:39], v12
    ds_read_b128 v[100:103], v14 offset:6656
    v_exp_f32 v43, v43
    v_exp_f32 v44, v44
    v_exp_f32 v45, v45
    v_exp_f32 v46, v46
    v_exp_f32 v47, v47
    v_exp_f32 v16, v16
    v_exp_f32 v17, v17
    v_exp_f32 v18, v18
    v_smfmac_f32_32x32x32_bf16 v[64:79], v[108:111], v[40:47], v12
    ds_read_b128 v[88:91], v13 offset:8192
    s_waitcnt lgkmcnt(1)
    v_exp_f32 v19, v19
    v_exp_f32 v20, v20
    v_exp_f32 v21, v21
    v_exp_f32 v22, v22
    v_mfma_f32_32x32x16_bf16 v[32:47], v[92:95], v[84:87], v[48:63]
    ds_read_b128 v[104:107], v14 offset:7168
    v_exp_f32 v23, v23
    v_exp_f32 v24, v24
    v_exp_f32 v25, v25
    v_exp_f32 v26, v26
    v_smfmac_f32_32x32x32_bf16 v[64:79], v[96:99], v[16:23], v12
    ds_read_b128 v[108:111], v14 offset:7680
    v_exp_f32 v27, v27
    v_exp_f32 v28, v28
    v_exp_f32 v29, v29
    v_exp_f32 v30, v30
    v_exp_f32 v31, v31
    v_exp_f32 v32, v32
    v_exp_f32 v33, v33
    v_exp_f32 v34, v34
    v_smfmac_f32_32x32x32_bf16 v[64:79], v[100:103], v[24:31], v12
    ds_read_b128 v[92:95], v13 offset:9216
    s_waitcnt lgkmcnt(1)
    v_exp_f32 v35, v35
    v_exp_f32 v36, v36
    v_exp_f32 v37, v37
    v_exp_f32 v38, v38
    v_mfma_f32_32x32x16_bf16 v[16:31], v[88:91], v[84:87], v[48:63]
    ds_read_b128 v[96:99], v14 offset:8192
    v_add_u32 v13, 8192, v13
    s_add_u32 s34, s34, 1
    v_exp_f32 v39, v39
    v_exp_f32 v40, v40
    v_exp_f32 v41, v41
    v_exp_f32 v42, v42
    v_smfmac_f32_32x32x32_bf16 v[64:79], v[104:107], v[32:39], v12
    ds_read_b128 v[100:103], v14 offset:8704
    v_add_u32 v14, v15, v14
    s_cmp_lt_u32 s34, 8
    v_exp_f32 v43, v43
    v_exp_f32 v44, v44
    v_exp_f32 v45, v45
    v_exp_f32 v46, v46
    v_exp_f32 v47, v47
    s_cbranch_scc1 attn_kernel_A_loop
    v_smfmac_f32_32x32x32_bf16 v[64:79], v[108:111], v[40:47], v12
    s_waitcnt vmcnt(0) lgkmcnt(0)
    v_mov_b64 v[48:49], 0
    v_mov_b64 v[50:51], 0
    v_mov_b64 v[52:53], 0
    v_mov_b64 v[54:55], 0
    v_mov_b64 v[56:57], 0
    v_mov_b64 v[58:59], 0
    v_mov_b64 v[60:61], 0
    v_mov_b64 v[62:63], 0
    s_mov_b32 s30, 0x76800000
    s_nop 3
    v_rcp_f32 v11, v72
    v_pk_mul_f32 v[8:9], v[64:65], 0
    v_pk_fma_f32 v[8:9], v[66:67], 0, v[8:9]
    v_pk_fma_f32 v[8:9], v[68:69], 0, v[8:9]
    v_pk_fma_f32 v[8:9], v[70:71], 0, v[8:9]
    v_cmp_ngt_f32 s[26:27], s30, v72
    v_cmp_u_f32 s[32:33], v8, v9
    s_or_b64 s[26:27], s[26:27], s[32:33]
    s_cmp_lg_u64 s[26:27], 0
    s_cselect_b32 s30, 1, 0
    s_andn2_b32 s30, s30, s29
    s_cbranch_scc1 attn_kernel_A_retry
    v_pk_mul_f32 v[64:65], v[64:65], v[10:11] op_sel:[0,1] op_sel_hi:[1,1]
    v_pk_mul_f32 v[66:67], v[66:67], v[10:11] op_sel:[0,1] op_sel_hi:[1,1]
    v_pk_mul_f32 v[68:69], v[68:69], v[10:11] op_sel:[0,1] op_sel_hi:[1,1]
    v_pk_mul_f32 v[70:71], v[70:71], v[10:11] op_sel:[0,1] op_sel_hi:[1,1]
    v_cvt_pk_bf16_f32 v8, v64, v65
    v_cvt_pk_bf16_f32 v9, v66, v67
    v_cvt_pk_bf16_f32 v10, v68, v69
    v_cvt_pk_bf16_f32 v11, v70, v71
    s_lshl_b32 s30, s8, 15
    s_lshl_b32 s31, s6, 10
    s_add_u32 s30, s30, s31
    s_add_u32 s30, s30, 0x900000
    buffer_store_dwordx4 v[8:11], v2, s[12:15], s30 offen sc0 sc1
    s_mov_b32 s29, 0
    s_mov_b32 s68, s48
    s_and_b32 s69, s49, 0xffff
    s_mov_b32 s70, 0x80000
    s_mov_b32 s71, 0x20000
    s_mov_b32 s36, s46
    s_and_b32 s37, s47, 0xffff
    s_mov_b32 s38, 0x80000
    s_mov_b32 s39, 0x20000
    s_mov_b32 s40, s50
    s_and_b32 s41, s51, 0xffff
    s_mov_b32 s42, 0x400000
    s_mov_b32 s43, 0x20000
    v_lshrrev_b32 v13, 3, v0
    v_and_b32 v14, 7, v0
    v_bfe_u32 v15, v0, 4, 1
    v_lshlrev_b32 v15, 2, v15
    v_xor_b32 v14, v14, v15
    v_lshlrev_b32 v14, 4, v14
    v_lshl_add_u32 v13, v13, 10, v14
    s_bfe_u32 s44, s2, 0x30003
    s_lshl_b32 s44, s44, 7
    s_and_b32 s45, s7, 3
    s_lshl_b32 s45, s45, 17
    s_add_u32 s45, s45, s44
    s_lshl_b32 s52, s7, 14
    s_lshr_b32 s53, s8, 1
    s_lshl_b32 s53, s53, 8
    s_add_u32 s53, s53, 0x824000
    s_cmp_lt_u32 s7, 4
    s_cselect_b32 s66, 1, 0
    v_mov_b32 v15, 0
    s_cmp_ge_u32 s7, 4
    s_cbranch_scc1 attn_kernel_B
    s_setprio 2
attn_kernel_B:
    v_mfma_f32_32x32x16_bf16 v[16:31], v[112:115], v[80:83], v[220:235]
    v_mov_b64 v[64:65], 0
    v_mov_b64 v[66:67], 0
    v_mov_b64 v[68:69], 0
    v_mov_b64 v[70:71], 0
    v_mov_b64 v[72:73], 0
    v_mov_b64 v[74:75], 0
    v_mov_b64 v[76:77], 0
    v_mov_b64 v[78:79], 0
    s_nop 4
    s_or_b32 s30, s29, s66
    s_cbranch_scc1 attn_kernel_sga
    s_barrier
attn_kernel_sga:
    v_exp_f32 v16, v16
    v_exp_f32 v17, v17
    v_exp_f32 v18, v18
    v_exp_f32 v19, v19
    v_exp_f32 v20, v20
    v_exp_f32 v21, v21
    v_exp_f32 v22, v22
    v_mfma_f32_32x32x16_bf16 v[32:47], v[116:119], v[80:83], v[48:63]
    v_exp_f32 v23, v23
    v_exp_f32 v24, v24
    v_exp_f32 v25, v25
    v_exp_f32 v26, v26
    v_smfmac_f32_32x32x32_bf16 v[64:79], v[148:151], v[16:23], v12
    s_cmp_eq_u32 s28, 0
    v_exp_f32 v27, v27
    v_exp_f32 v28, v28
    v_exp_f32 v29, v29
    v_exp_f32 v30, v30
    v_exp_f32 v31, v31
    s_cbranch_scc1 attn_kernel_B_end0
    v_exp_f32 v32, v32
    v_exp_f32 v33, v33
    v_exp_f32 v34, v34
    v_smfmac_f32_32x32x32_bf16 v[64:79], v[152:155], v[24:31], v12
    v_exp_f32 v35, v35
    v_exp_f32 v36, v36
    v_exp_f32 v37, v37
    v_exp_f32 v38, v38
    v_mfma_f32_32x32x16_bf16 v[16:31], v[120:123], v[80:83], v[48:63]
    v_exp_f32 v39, v39
    v_exp_f32 v40, v40
    v_exp_f32 v41, v41
    v_exp_f32 v42, v42
    v_smfmac_f32_32x32x32_bf16 v[64:79], v[156:159], v[32:39], v12
    s_cmp_eq_u32 s28, 1
    v_exp_f32 v43, v43
    v_exp_f32 v44, v44
    v_exp_f32 v45, v45
    v_exp_f32 v46, v46
    v_exp_f32 v47, v47
    s_cbranch_scc1 attn_kernel_B_end1
    v_exp_f32 v16, v16
    v_exp_f32 v17, v17
    v_exp_f32 v18, v18
    v_smfmac_f32_32x32x32_bf16 v[64:79], v[160:163], v[40:47], v12
    v_exp_f32 v19, v19
    v_exp_f32 v20, v20
    v_exp_f32 v21, v21
    v_exp_f32 v22, v22
    v_mfma_f32_32x32x16_bf16 v[32:47], v[124:127], v[80:83], v[48:63]
    v_exp_f32 v23, v23
    v_exp_f32 v24, v24
    v_exp_f32 v25, v25
    v_exp_f32 v26, v26
    v_smfmac_f32_32x32x32_bf16 v[64:79], v[164:167], v[16:23], v12
    s_cmp_eq_u32 s28, 2
    v_exp_f32 v27, v27
    v_exp_f32 v28, v28
    v_exp_f32 v29, v29
    v_exp_f32 v30, v30
    v_exp_f32 v31, v31
    s_cbranch_scc1 attn_kernel_B_end2
    v_exp_f32 v32, v32
    v_exp_f32 v33, v33
    v_exp_f32 v34, v34
    v_smfmac_f32_32x32x32_bf16 v[64:79], v[168:171], v[24:31], v12
    v_exp_f32 v35, v35
    v_exp_f32 v36, v36
    v_exp_f32 v37, v37
    v_exp_f32 v38, v38
    v_mfma_f32_32x32x16_bf16 v[16:31], v[128:131], v[80:83], v[48:63]
    v_exp_f32 v39, v39
    v_exp_f32 v40, v40
    v_exp_f32 v41, v41
    v_exp_f32 v42, v42
    v_smfmac_f32_32x32x32_bf16 v[64:79], v[172:175], v[32:39], v12
    s_cmp_eq_u32 s28, 3
    v_exp_f32 v43, v43
    v_exp_f32 v44, v44
    v_exp_f32 v45, v45
    v_exp_f32 v46, v46
    v_exp_f32 v47, v47
    s_cbranch_scc1 attn_kernel_B_end3
    v_exp_f32 v16, v16
    v_exp_f32 v17, v17
    v_exp_f32 v18, v18
    v_smfmac_f32_32x32x32_bf16 v[64:79], v[176:179], v[40:47], v12
    v_exp_f32 v19, v19
    v_exp_f32 v20, v20
    v_exp_f32 v21, v21
    v_exp_f32 v22, v22
    v_mfma_f32_32x32x16_bf16 v[32:47], v[132:135], v[80:83], v[48:63]
    v_exp_f32 v23, v23
    v_exp_f32 v24, v24
    v_exp_f32 v25, v25
    v_exp_f32 v26, v26
    v_smfmac_f32_32x32x32_bf16 v[64:79], v[180:183], v[16:23], v12
    s_cmp_eq_u32 s28, 4
    v_exp_f32 v27, v27
    v_exp_f32 v28, v28
    v_exp_f32 v29, v29
    v_exp_f32 v30, v30
    v_exp_f32 v31, v31
    s_cbranch_scc1 attn_kernel_B_end4
    v_exp_f32 v32, v32
    v_exp_f32 v33, v33
    v_exp_f32 v34, v34
    v_smfmac_f32_32x32x32_bf16 v[64:79], v[184:187], v[24:31], v12
    v_exp_f32 v35, v35
    v_exp_f32 v36, v36
    v_exp_f32 v37, v37
    v_exp_f32 v38, v38
    v_mfma_f32_32x32x16_bf16 v[16:31], v[136:139], v[80:83], v[48:63]
    v_exp_f32 v39, v39
    v_exp_f32 v40, v40
    v_exp_f32 v41, v41
    v_exp_f32 v42, v42
    v_smfmac_f32_32x32x32_bf16 v[64:79], v[188:191], v[32:39], v12
    buffer_load_dword v15, off, s[12:15], s53 sc1
    s_cmp_eq_u32 s28, 5
    v_exp_f32 v43, v43
    v_exp_f32 v44, v44
    v_exp_f32 v45, v45
    v_exp_f32 v46, v46
    v_exp_f32 v47, v47
    s_cbranch_scc1 attn_kernel_B_end5
    v_exp_f32 v16, v16
    v_exp_f32 v17, v17
    v_exp_f32 v18, v18
    v_smfmac_f32_32x32x32_bf16 v[64:79], v[192:195], v[40:47], v12
    v_exp_f32 v19, v19
    v_exp_f32 v20, v20
    v_exp_f32 v21, v21
    v_exp_f32 v22, v22
    v_mfma_f32_32x32x16_bf16 v[32:47], v[140:143], v[80:83], v[48:63]
    v_exp_f32 v23, v23
    v_exp_f32 v24, v24
    v_exp_f32 v25, v25
    v_exp_f32 v26, v26
    v_smfmac_f32_32x32x32_bf16 v[64:79], v[196:199], v[16:23], v12
    s_cmp_eq_u32 s28, 6
    v_exp_f32 v27, v27
    v_exp_f32 v28, v28
    v_exp_f32 v29, v29
    v_exp_f32 v30, v30
    v_exp_f32 v31, v31
    s_cbranch_scc1 attn_kernel_B_end6
    v_exp_f32 v32, v32
    v_exp_f32 v33, v33
    v_exp_f32 v34, v34
    v_smfmac_f32_32x32x32_bf16 v[64:79], v[200:203], v[24:31], v12
    v_exp_f32 v35, v35
    v_exp_f32 v36, v36
    v_exp_f32 v37, v37
    v_exp_f32 v38, v38
    v_mfma_f32_32x32x16_bf16 v[16:31], v[144:147], v[80:83], v[236:251]
    v_exp_f32 v39, v39
    v_exp_f32 v40, v40
    v_exp_f32 v41, v41
    v_exp_f32 v42, v42
    v_smfmac_f32_32x32x32_bf16 v[64:79], v[204:207], v[32:39], v12
    s_cmp_eq_u32 s28, 7
    v_exp_f32 v43, v43
    v_exp_f32 v44, v44
    v_exp_f32 v45, v45
    v_exp_f32 v46, v46
    v_exp_f32 v47, v47
    s_cbranch_scc1 attn_kernel_B_end7
    v_exp_f32 v16, v16
    v_exp_f32 v17, v17
    v_exp_f32 v18, v18
    v_smfmac_f32_32x32x32_bf16 v[64:79], v[208:211], v[40:47], v12
    v_exp_f32 v19, v19
    v_exp_f32 v20, v20
    v_exp_f32 v21, v21
    v_exp_f32 v22, v22
    v_exp_f32 v23, v23
    v_exp_f32 v24, v24
    v_exp_f32 v25, v25
    v_exp_f32 v26, v26
    v_smfmac_f32_32x32x32_bf16 v[64:79], v[212:215], v[16:23], v12
    v_exp_f32 v27, v27
    v_exp_f32 v28, v28
    v_exp_f32 v29, v29
    v_exp_f32 v30, v30
    v_exp_f32 v31, v31
    s_nop 1
    v_smfmac_f32_32x32x32_bf16 v[64:79], v[216:219], v[24:31], v12
attn_kernel_B_fin:
    s_mov_b32 s30, 0x76800000
    s_nop 11
    v_rcp_f32 v11, v72
    v_pk_mul_f32 v[8:9], v[64:65], 0
    v_pk_fma_f32 v[8:9], v[66:67], 0, v[8:9]
    v_pk_fma_f32 v[8:9], v[68:69], 0, v[8:9]
    v_pk_fma_f32 v[8:9], v[70:71], 0, v[8:9]
    v_cmp_ngt_f32 s[26:27], s30, v72
    v_cmp_u_f32 s[32:33], v8, v9
    s_or_b64 s[26:27], s[26:27], s[32:33]
    s_mov_b32 s30, 0x1f800000
    v_cmp_gt_f32 s[32:33], s30, v72
    s_or_b64 s[26:27], s[26:27], s[32:33]
    s_cmp_lg_u64 s[26:27], 0
    s_cselect_b32 s30, 1, 0
    s_andn2_b32 s30, s30, s29
    s_cbranch_scc1 attn_kernel_B_retry
    v_pk_mul_f32 v[64:65], v[64:65], v[10:11] op_sel:[0,1] op_sel_hi:[1,1]
    v_pk_mul_f32 v[66:67], v[66:67], v[10:11] op_sel:[0,1] op_sel_hi:[1,1]
    v_pk_mul_f32 v[68:69], v[68:69], v[10:11] op_sel:[0,1] op_sel_hi:[1,1]
    v_pk_mul_f32 v[70:71], v[70:71], v[10:11] op_sel:[0,1] op_sel_hi:[1,1]
    v_cvt_pk_bf16_f32 v8, v64, v65
    v_cvt_pk_bf16_f32 v9, v66, v67
    v_cvt_pk_bf16_f32 v10, v68, v69
    v_cvt_pk_bf16_f32 v11, v70, v71
    s_lshl_b32 s30, s8, 15
    s_lshl_b32 s31, s6, 10
    s_add_u32 s30, s30, s31
    s_add_u32 s30, s30, 0xb00000
    buffer_store_dwordx4 v[8:11], v2, s[12:15], s30 offen sc0 sc1
    s_and_b32 s55, s7, 1
    s_bfe_u32 s56, s7, 0x10001
    s_lshr_b32 s57, s7, 2
    s_xor_b32 s57, s57, 0
    s_and_b32 s58, s8, 0x3e
    s_add_u32 s58, s58, s56
    s_lshl_b32 s59, s57, 21
    s_lshl_b32 s60, s58, 15
    s_add_u32 s59, s59, s60
    s_lshl_b32 s60, s55, 14
    s_add_u32 s59, s59, s60
    s_add_u32 s59, s59, 0x900000
    s_lshl_b32 s60, s57, 7
    s_add_u32 s60, s60, s53
    s_lshl_b32 s61, s57, 16
    s_lshl_b32 s62, s55, 15
    s_add_u32 s61, s61, s62
    s_lshl_b32 s62, s55, 6
    v_bfe_u32 v4, v0, 2, 2
    v_lshrrev_b32 v1, 5, v0
    v_lshl_add_u32 v4, v1, 2, v4
    v_lshlrev_b32 v4, 7, v4
    v_and_b32 v5, 1, v0
    v_bfe_u32 v6, v0, 4, 1
    v_lshl_add_u32 v5, v5, 1, v6
    v_bfe_u32 v6, v0, 3, 1
    v_lshl_add_u32 v5, v6, 2, v5
    v_lshl_add_u32 v4, v5, 4, v4
    v_bfe_u32 v6, v0, 1, 1
    v_lshl_add_u32 v4, v6, 3, v4
    v_xor_b32 v4, s62, v4
    v_add_u32 v4, s61, v4
    v_xor_b32 v5, 64, v4
    s_lshl_b32 s61, s7, 12
    s_add_u32 s61, s61, 0x20000
    s_xor_b32 s63, s61, 0x1000
    v_add_u32 v6, s63, v2
    v_add_u32 v7, s61, v2
    v_and_b32 v3, 31, v0
    v_lshlrev_b32 v1, 1, v1
    v_bfe_u32 v12, v0, 1, 2
    v_xor_b32 v1, v1, v12
    v_lshlrev_b32 v1, 4, v1
    v_lshl_add_u32 v1, v3, 6, v1
    v_add_u32 v64, s61, v1
    v_xor_b32 v65, 16, v64
    v_and_b32 v3, 3, v0
    v_bfe_u32 v12, v0, 3, 2
    v_xor_b32 v12, v12, v3
    v_lshrrev_b32 v1, 2, v0
    v_lshlrev_b32 v12, 4, v12
    v_lshl_add_u32 v12, v1, 6, v12
    v_add_u32 v66, s61, v12
    v_lshlrev_b32 v1, 11, v1
    v_lshl_add_u32 v67, v3, 4, v1
    s_lshl_b32 s58, s58, 16
    s_lshl_b32 s57, s57, 10
    s_add_u32 s58, s58, s57
    s_add_u32 s58, s58, s44
    s_add_u32 s58, s58, s62
    s_mov_b32 s64, 0x10000
    v_mov_b64 v[16:17], 0
    v_mov_b64 v[18:19], 0
    v_mov_b64 v[20:21], 0
    v_mov_b64 v[22:23], 0
    v_mov_b64 v[24:25], 0
    v_mov_b64 v[26:27], 0
    v_mov_b64 v[28:29], 0
    v_mov_b64 v[30:31], 0
    v_mov_b64 v[32:33], 0
    v_mov_b64 v[34:35], 0
    v_mov_b64 v[36:37], 0
    v_mov_b64 v[38:39], 0
    v_mov_b64 v[40:41], 0
    v_mov_b64 v[42:43], 0
    v_mov_b64 v[44:45], 0
    v_mov_b64 v[46:47], 0
    v_lshlrev_b32 v1, 10, v0
    v_add_u32 v1, 1008, v1
    s_mov_b32 s60, s53
    s_cmp_lg_u32 s57, 0
    s_cbranch_scc1 attn_kernel_tb
    s_setprio 0
    s_add_u32 s54, s45, 0
    buffer_load_dwordx4 v[112:115], v13, s[36:39], s54 offen
    s_add_u32 s54, s45, 8192
    buffer_load_dwordx4 v[116:119], v13, s[36:39], s54 offen
    s_add_u32 s54, s45, 16384
    buffer_load_dwordx4 v[120:123], v13, s[36:39], s54 offen
    s_add_u32 s54, s45, 24576
    buffer_load_dwordx4 v[124:127], v13, s[36:39], s54 offen
    s_add_u32 s54, s45, 32768
    buffer_load_dwordx4 v[128:131], v13, s[36:39], s54 offen
    s_add_u32 s54, s45, 40960
    buffer_load_dwordx4 v[132:135], v13, s[36:39], s54 offen
    s_add_u32 s54, s45, 49152
    buffer_load_dwordx4 v[136:139], v13, s[36:39], s54 offen
    s_add_u32 s54, s45, 57344
    buffer_load_dwordx4 v[140:143], v13, s[36:39], s54 offen
    s_add_u32 s54, s45, 65536
    buffer_load_dwordx4 v[144:147], v13, s[36:39], s54 offen
    s_add_u32 s54, s45, 73728
    buffer_load_dwordx4 v[148:151], v13, s[36:39], s54 offen
    s_add_u32 s54, s45, 81920
    buffer_load_dwordx4 v[152:155], v13, s[36:39], s54 offen
    s_add_u32 s54, s45, 90112
    buffer_load_dwordx4 v[156:159], v13, s[36:39], s54 offen
    s_add_u32 s54, s45, 98304
    buffer_load_dwordx4 v[160:163], v13, s[36:39], s54 offen
    s_add_u32 s54, s45, 106496
    buffer_load_dwordx4 v[164:167], v13, s[36:39], s54 offen
    s_add_u32 s54, s45, 114688
    buffer_load_dwordx4 v[168:171], v13, s[36:39], s54 offen
    s_add_u32 s54, s45, 122880
    buffer_load_dwordx4 v[172:175], v13, s[36:39], s54 offen
    s_add_u32 s54, s45, 0
    buffer_load_dwordx4 v[176:179], v13, s[68:71], s54 offen
    s_add_u32 s54, s45, 8192
    buffer_load_dwordx4 v[180:183], v13, s[68:71], s54 offen
    s_add_u32 s54, s45, 16384
    buffer_load_dwordx4 v[184:187], v13, s[68:71], s54 offen
    s_add_u32 s54, s45, 24576
    buffer_load_dwordx4 v[188:191], v13, s[68:71], s54 offen
    s_add_u32 s54, s45, 32768
    buffer_load_dwordx4 v[192:195], v13, s[68:71], s54 offen
    s_add_u32 s54, s45, 40960
    buffer_load_dwordx4 v[196:199], v13, s[68:71], s54 offen
    s_add_u32 s54, s45, 49152
    buffer_load_dwordx4 v[200:203], v13, s[68:71], s54 offen
    s_add_u32 s54, s45, 57344
    buffer_load_dwordx4 v[204:207], v13, s[68:71], s54 offen
    s_add_u32 s54, s45, 65536
    buffer_load_dwordx4 v[208:211], v13, s[68:71], s54 offen
    s_add_u32 s54, s45, 73728
    buffer_load_dwordx4 v[212:215], v13, s[68:71], s54 offen
    s_add_u32 s54, s45, 81920
    buffer_load_dwordx4 v[216:219], v13, s[68:71], s54 offen
    s_add_u32 s54, s45, 90112
    buffer_load_dwordx4 v[220:223], v13, s[68:71], s54 offen
    s_add_u32 s54, s45, 98304
    buffer_load_dwordx4 v[224:227], v13, s[68:71], s54 offen
    s_add_u32 s54, s45, 106496
    buffer_load_dwordx4 v[228:231], v13, s[68:71], s54 offen
    s_add_u32 s54, s45, 114688
    buffer_load_dwordx4 v[232:235], v13, s[68:71], s54 offen
    s_add_u32 s54, s45, 122880
    buffer_load_dwordx4 v[236:239], v13, s[68:71], s54 offen
    v_add_u32 v8, s52, v2
    v_add_u32 v9, 0x10000, v8
    s_mov_b32 s65, 0
    s_barrier
    s_setprio 2
    s_waitcnt vmcnt(31)
    ds_write_b128 v8, v[112:115] offset:0
    s_waitcnt vmcnt(30)
    ds_write_b128 v8, v[116:119] offset:1024
    s_waitcnt vmcnt(29)
    ds_write_b128 v8, v[120:123] offset:2048
    s_waitcnt vmcnt(28)
    ds_write_b128 v8, v[124:127] offset:3072
    s_waitcnt vmcnt(27)
    ds_write_b128 v8, v[128:131] offset:4096
    s_waitcnt vmcnt(26)
    ds_write_b128 v8, v[132:135] offset:5120
    s_waitcnt vmcnt(25)
    ds_write_b128 v8, v[136:139] offset:6144
    s_waitcnt vmcnt(24)
    ds_write_b128 v8, v[140:143] offset:7168
    s_waitcnt vmcnt(23)
    ds_write_b128 v8, v[144:147] offset:8192
    s_waitcnt vmcnt(22)
    ds_write_b128 v8, v[148:151] offset:9216
    s_waitcnt vmcnt(21)
    ds_write_b128 v8, v[152:155] offset:10240
    s_waitcnt vmcnt(20)
    ds_write_b128 v8, v[156:159] offset:11264
    s_waitcnt vmcnt(19)
    ds_write_b128 v8, v[160:163] offset:12288
    s_mov_b64 exec, 0xffff
    buffer_load_dword v15, off, s[12:15], s60 sc1
    buffer_load_dword v3, v1, s[12:15], s59 offen sc1
    s_mov_b64 exec, -1
    s_waitcnt vmcnt(20)
    ds_write_b128 v8, v[164:167] offset:13312
    s_waitcnt vmcnt(19)
    ds_write_b128 v8, v[168:171] offset:14336
    s_waitcnt vmcnt(18)
    ds_write_b128 v8, v[172:175] offset:15360
    s_mov_b64 exec, 0xffff
    s_branch attn_kernel_qw
attn_kernel_qr:
    buffer_load_dword v15, off, s[12:15], s60 sc1
    buffer_load_dword v3, v1, s[12:15], s59 offen sc1
    s_sub_u32 s64, s64, 1
    s_cmp_lt_i32 s64, 0
    s_cbranch_scc1 attn_kernel_qe
attn_kernel_qw:
    s_waitcnt vmcnt(0)
    v_cmp_eq_u32 vcc, -1, v3
    s_cbranch_vccnz attn_kernel_qr
    v_cmp_gt_u32 vcc, 64, v15
    s_cbranch_vccnz attn_kernel_qr
attn_kernel_qe:
    s_mov_b64 exec, -1
    s_waitcnt vmcnt(0) lgkmcnt(0)
    s_add_u32 s63, s59, 0
    buffer_load_dwordx4 v[112:115], v2, s[12:15], s63 offen offset:0 sc1
    ds_write_b128 v9, v[176:179] offset:0
    buffer_load_dwordx4 v[116:119], v2, s[12:15], s63 offen offset:1024 sc1
    ds_write_b128 v9, v[180:183] offset:1024
    buffer_load_dwordx4 v[120:123], v2, s[12:15], s63 offen offset:2048 sc1
    ds_write_b128 v9, v[184:187] offset:2048
    buffer_load_dwordx4 v[124:127], v2, s[12:15], s63 offen offset:3072 sc1
    ds_write_b128 v9, v[188:191] offset:3072
    s_add_u32 s63, s59, 8192
    buffer_load_dwordx4 v[128:131], v2, s[12:15], s63 offen offset:0 sc1
    ds_write_b128 v9, v[192:195] offset:4096
    buffer_load_dwordx4 v[132:135], v2, s[12:15], s63 offen offset:1024 sc1
    ds_write_b128 v9, v[196:199] offset:5120
    buffer_load_dwordx4 v[136:139], v2, s[12:15], s63 offen offset:2048 sc1
    ds_write_b128 v9, v[200:203] offset:6144
    buffer_load_dwordx4 v[140:143], v2, s[12:15], s63 offen offset:3072 sc1
    ds_write_b128 v9, v[204:207] offset:7168
    s_add_u32 s63, s59, 4096
    buffer_load_dwordx4 v[144:147], v2, s[12:15], s63 offen offset:0 sc1
    ds_write_b128 v9, v[208:211] offset:8192
    buffer_load_dwordx4 v[148:151], v2, s[12:15], s63 offen offset:1024 sc1
    ds_write_b128 v9, v[212:215] offset:9216
    buffer_load_dwordx4 v[152:155], v2, s[12:15], s63 offen offset:2048 sc1
    ds_write_b128 v9, v[216:219] offset:10240
    buffer_load_dwordx4 v[156:159], v2, s[12:15], s63 offen offset:3072 sc1
    ds_write_b128 v9, v[220:223] offset:11264
    s_add_u32 s63, s59, 12288
    buffer_load_dwordx4 v[160:163], v2, s[12:15], s63 offen offset:0 sc1
    ds_write_b128 v9, v[224:227] offset:12288
    buffer_load_dwordx4 v[164:167], v2, s[12:15], s63 offen offset:1024 sc1
    ds_write_b128 v9, v[228:231] offset:13312
    buffer_load_dwordx4 v[168:171], v2, s[12:15], s63 offen offset:2048 sc1
    ds_write_b128 v9, v[232:235] offset:14336
    buffer_load_dwordx4 v[172:175], v2, s[12:15], s63 offen offset:3072 sc1
    ds_write_b128 v9, v[236:239] offset:15360
    s_waitcnt lgkmcnt(0)
    s_barrier
    s_branch attn_kernel_nb
attn_kernel_tb:
    s_waitcnt vmcnt(1)
    s_mov_b64 exec, 1
    s_branch attn_kernel_pcb
attn_kernel_pollb:
    buffer_load_dword v15, off, s[12:15], s60 sc1
    s_sub_u32 s64, s64, 1
    s_cbranch_scc1 attn_kernel_pdb
    s_waitcnt vmcnt(0)
attn_kernel_pcb:
    v_readfirstlane_b32 s63, v15
    s_cmp_lt_u32 s63, 64
    s_cbranch_scc1 attn_kernel_pollb
attn_kernel_pdb:
    s_mov_b64 exec, -1
    s_barrier
    s_mov_b32 s65, 1
    s_mov_b64 exec, 0xffff
    buffer_load_dword v3, v1, s[12:15], s59 offen sc1
    s_mov_b64 exec, -1
    s_add_u32 s63, s59, 0
    buffer_load_dwordx4 v[112:115], v2, s[12:15], s63 offen offset:0 sc1
    buffer_load_dwordx4 v[116:119], v2, s[12:15], s63 offen offset:1024 sc1
    buffer_load_dwordx4 v[120:123], v2, s[12:15], s63 offen offset:2048 sc1
    buffer_load_dwordx4 v[124:127], v2, s[12:15], s63 offen offset:3072 sc1
    s_add_u32 s63, s59, 8192
    buffer_load_dwordx4 v[128:131], v2, s[12:15], s63 offen offset:0 sc1
    buffer_load_dwordx4 v[132:135], v2, s[12:15], s63 offen offset:1024 sc1
    buffer_load_dwordx4 v[136:139], v2, s[12:15], s63 offen offset:2048 sc1
    buffer_load_dwordx4 v[140:143], v2, s[12:15], s63 offen offset:3072 sc1
    s_mov_b64 exec, 0xffff
    s_waitcnt vmcnt(8)
    s_branch attn_kernel_yc
attn_kernel_yr:
    buffer_load_dword v3, v1, s[12:15], s59 offen sc1
    s_sub_u32 s64, s64, 1
    s_cmp_lt_i32 s64, 0
    s_cbranch_scc1 attn_kernel_ye
    s_waitcnt vmcnt(0)
attn_kernel_yc:
    v_cmp_eq_u32 vcc, -1, v3
    s_cbranch_vccnz attn_kernel_yr
    s_branch attn_kernel_yf
attn_kernel_ye:
    s_waitcnt vmcnt(0)
attn_kernel_yf:
    s_mov_b64 exec, -1
    s_add_u32 s63, s59, 4096
    buffer_load_dwordx4 v[144:147], v2, s[12:15], s63 offen offset:0 sc1
    buffer_load_dwordx4 v[148:151], v2, s[12:15], s63 offen offset:1024 sc1
    buffer_load_dwordx4 v[152:155], v2, s[12:15], s63 offen offset:2048 sc1
    buffer_load_dwordx4 v[156:159], v2, s[12:15], s63 offen offset:3072 sc1
    s_add_u32 s63, s59, 12288
    buffer_load_dwordx4 v[160:163], v2, s[12:15], s63 offen offset:0 sc1
    buffer_load_dwordx4 v[164:167], v2, s[12:15], s63 offen offset:1024 sc1
    buffer_load_dwordx4 v[168:171], v2, s[12:15], s63 offen offset:2048 sc1
    buffer_load_dwordx4 v[172:175], v2, s[12:15], s63 offen offset:3072 sc1
    s_branch attn_kernel_nb
attn_kernel_tr:
    s_mov_b64 exec, 0xffff
attn_kernel_pr:
    buffer_load_dword v15, off, s[12:15], s60 sc1
    buffer_load_dword v3, v1, s[12:15], s59 offen sc1
    s_sub_u32 s64, s64, 1
    s_cmp_lt_i32 s64, 0
    s_cbranch_scc1 attn_kernel_pe
attn_kernel_pw:
    s_waitcnt vmcnt(0)
    v_cmp_eq_u32 vcc, -1, v3
    s_cbranch_vccnz attn_kernel_pr
    v_cmp_gt_u32 vcc, 64, v15
    s_cbranch_vccnz attn_kernel_pr
attn_kernel_pe:
    s_mov_b64 exec, -1
    s_waitcnt vmcnt(0) lgkmcnt(0)
    s_add_u32 s63, s59, 0
    buffer_load_dwordx4 v[112:115], v2, s[12:15], s63 offen offset:0 sc1
    buffer_load_dwordx4 v[116:119], v2, s[12:15], s63 offen offset:1024 sc1
    buffer_load_dwordx4 v[120:123], v2, s[12:15], s63 offen offset:2048 sc1
    buffer_load_dwordx4 v[124:127], v2, s[12:15], s63 offen offset:3072 sc1
    s_add_u32 s63, s59, 8192
    buffer_load_dwordx4 v[128:131], v2, s[12:15], s63 offen offset:0 sc1
    buffer_load_dwordx4 v[132:135], v2, s[12:15], s63 offen offset:1024 sc1
    buffer_load_dwordx4 v[136:139], v2, s[12:15], s63 offen offset:2048 sc1
    buffer_load_dwordx4 v[140:143], v2, s[12:15], s63 offen offset:3072 sc1
    s_add_u32 s63, s59, 4096
    buffer_load_dwordx4 v[144:147], v2, s[12:15], s63 offen offset:0 sc1
    buffer_load_dwordx4 v[148:151], v2, s[12:15], s63 offen offset:1024 sc1
    buffer_load_dwordx4 v[152:155], v2, s[12:15], s63 offen offset:2048 sc1
    buffer_load_dwordx4 v[156:159], v2, s[12:15], s63 offen offset:3072 sc1
    s_add_u32 s63, s59, 12288
    buffer_load_dwordx4 v[160:163], v2, s[12:15], s63 offen offset:0 sc1
    buffer_load_dwordx4 v[164:167], v2, s[12:15], s63 offen offset:1024 sc1
    buffer_load_dwordx4 v[168:171], v2, s[12:15], s63 offen offset:2048 sc1
    buffer_load_dwordx4 v[172:175], v2, s[12:15], s63 offen offset:3072 sc1
    s_cmp_lg_u32 s65, 0
    s_cbranch_scc1 attn_kernel_nb
    s_barrier
attn_kernel_nb:
    ds_read_b64_tr_b16 v[48:49], v4 offset:0
    ds_read_b64_tr_b16 v[50:51], v4 offset:1024
    ds_read_b64_tr_b16 v[52:53], v5 offset:0
    ds_read_b64_tr_b16 v[54:55], v5 offset:1024
    ds_read_b64_tr_b16 v[56:57], v4 offset:2048
    ds_read_b64_tr_b16 v[58:59], v4 offset:3072
    ds_read_b64_tr_b16 v[60:61], v5 offset:2048
    ds_read_b64_tr_b16 v[62:63], v5 offset:3072
    s_waitcnt vmcnt(15) lgkmcnt(4)
    v_mfma_f32_32x32x16_bf16 v[16:31], v[48:51], v[112:115], v[16:31]
    v_mfma_f32_32x32x16_bf16 v[32:47], v[52:55], v[112:115], v[32:47]
    ds_read_b64_tr_b16 v[48:49], v4 offset:4096
    ds_read_b64_tr_b16 v[50:51], v4 offset:5120
    ds_read_b64_tr_b16 v[52:53], v5 offset:4096
    ds_read_b64_tr_b16 v[54:55], v5 offset:5120
    s_waitcnt vmcnt(14) lgkmcnt(4)
    v_mfma_f32_32x32x16_bf16 v[16:31], v[56:59], v[116:119], v[16:31]
    v_mfma_f32_32x32x16_bf16 v[32:47], v[60:63], v[116:119], v[32:47]
    v_max_u32 v3, v112, v116
    ds_read_b64_tr_b16 v[56:57], v4 offset:6144
    ds_read_b64_tr_b16 v[58:59], v4 offset:7168
    ds_read_b64_tr_b16 v[60:61], v5 offset:6144
    ds_read_b64_tr_b16 v[62:63], v5 offset:7168
    s_waitcnt vmcnt(13) lgkmcnt(4)
    v_mfma_f32_32x32x16_bf16 v[16:31], v[48:51], v[120:123], v[16:31]
    v_mfma_f32_32x32x16_bf16 v[32:47], v[52:55], v[120:123], v[32:47]
    ds_read_b64_tr_b16 v[48:49], v4 offset:16384
    ds_read_b64_tr_b16 v[50:51], v4 offset:17408
    ds_read_b64_tr_b16 v[52:53], v5 offset:16384
    ds_read_b64_tr_b16 v[54:55], v5 offset:17408
    s_waitcnt vmcnt(12) lgkmcnt(4)
    v_mfma_f32_32x32x16_bf16 v[16:31], v[56:59], v[124:127], v[16:31]
    v_mfma_f32_32x32x16_bf16 v[32:47], v[60:63], v[124:127], v[32:47]
    v_max3_u32 v3, v3, v120, v124
    ds_read_b64_tr_b16 v[56:57], v4 offset:18432
    ds_read_b64_tr_b16 v[58:59], v4 offset:19456
    ds_read_b64_tr_b16 v[60:61], v5 offset:18432
    ds_read_b64_tr_b16 v[62:63], v5 offset:19456
    s_waitcnt vmcnt(11) lgkmcnt(4)
    v_mfma_f32_32x32x16_bf16 v[16:31], v[48:51], v[128:131], v[16:31]
    v_mfma_f32_32x32x16_bf16 v[32:47], v[52:55], v[128:131], v[32:47]
    ds_read_b64_tr_b16 v[48:49], v4 offset:20480
    ds_read_b64_tr_b16 v[50:51], v4 offset:21504
    ds_read_b64_tr_b16 v[52:53], v5 offset:20480
    ds_read_b64_tr_b16 v[54:55], v5 offset:21504
    s_waitcnt vmcnt(10) lgkmcnt(4)
    v_mfma_f32_32x32x16_bf16 v[16:31], v[56:59], v[132:135], v[16:31]
    v_mfma_f32_32x32x16_bf16 v[32:47], v[60:63], v[132:135], v[32:47]
    v_max3_u32 v3, v3, v128, v132
    ds_read_b64_tr_b16 v[56:57], v4 offset:22528
    ds_read_b64_tr_b16 v[58:59], v4 offset:23552
    ds_read_b64_tr_b16 v[60:61], v5 offset:22528
    ds_read_b64_tr_b16 v[62:63], v5 offset:23552
    s_waitcnt vmcnt(9) lgkmcnt(4)
    v_mfma_f32_32x32x16_bf16 v[16:31], v[48:51], v[136:139], v[16:31]
    v_mfma_f32_32x32x16_bf16 v[32:47], v[52:55], v[136:139], v[32:47]
    ds_read_b64_tr_b16 v[48:49], v4 offset:8192
    ds_read_b64_tr_b16 v[50:51], v4 offset:9216
    ds_read_b64_tr_b16 v[52:53], v5 offset:8192
    ds_read_b64_tr_b16 v[54:55], v5 offset:9216
    s_waitcnt vmcnt(8) lgkmcnt(4)
    v_mfma_f32_32x32x16_bf16 v[16:31], v[56:59], v[140:143], v[16:31]
    v_mfma_f32_32x32x16_bf16 v[32:47], v[60:63], v[140:143], v[32:47]
    v_max3_u32 v3, v3, v136, v140
    ds_read_b64_tr_b16 v[56:57], v4 offset:10240
    ds_read_b64_tr_b16 v[58:59], v4 offset:11264
    ds_read_b64_tr_b16 v[60:61], v5 offset:10240
    ds_read_b64_tr_b16 v[62:63], v5 offset:11264
    s_waitcnt vmcnt(7) lgkmcnt(4)
    v_mfma_f32_32x32x16_bf16 v[16:31], v[48:51], v[144:147], v[16:31]
    v_mfma_f32_32x32x16_bf16 v[32:47], v[52:55], v[144:147], v[32:47]
    ds_read_b64_tr_b16 v[48:49], v4 offset:12288
    ds_read_b64_tr_b16 v[50:51], v4 offset:13312
    ds_read_b64_tr_b16 v[52:53], v5 offset:12288
    ds_read_b64_tr_b16 v[54:55], v5 offset:13312
    s_waitcnt vmcnt(6) lgkmcnt(4)
    v_mfma_f32_32x32x16_bf16 v[16:31], v[56:59], v[148:151], v[16:31]
    v_mfma_f32_32x32x16_bf16 v[32:47], v[60:63], v[148:151], v[32:47]
    v_max3_u32 v3, v3, v144, v148
    ds_read_b64_tr_b16 v[56:57], v4 offset:14336
    ds_read_b64_tr_b16 v[58:59], v4 offset:15360
    ds_read_b64_tr_b16 v[60:61], v5 offset:14336
    ds_read_b64_tr_b16 v[62:63], v5 offset:15360
    s_waitcnt vmcnt(5) lgkmcnt(4)
    v_mfma_f32_32x32x16_bf16 v[16:31], v[48:51], v[152:155], v[16:31]
    v_mfma_f32_32x32x16_bf16 v[32:47], v[52:55], v[152:155], v[32:47]
    ds_read_b64_tr_b16 v[48:49], v4 offset:24576
    ds_read_b64_tr_b16 v[50:51], v4 offset:25600
    ds_read_b64_tr_b16 v[52:53], v5 offset:24576
    ds_read_b64_tr_b16 v[54:55], v5 offset:25600
    s_waitcnt vmcnt(4) lgkmcnt(4)
    v_mfma_f32_32x32x16_bf16 v[16:31], v[56:59], v[156:159], v[16:31]
    v_mfma_f32_32x32x16_bf16 v[32:47], v[60:63], v[156:159], v[32:47]
    v_max3_u32 v3, v3, v152, v156
    ds_read_b64_tr_b16 v[56:57], v4 offset:26624
    ds_read_b64_tr_b16 v[58:59], v4 offset:27648
    ds_read_b64_tr_b16 v[60:61], v5 offset:26624
    ds_read_b64_tr_b16 v[62:63], v5 offset:27648
    s_waitcnt vmcnt(3) lgkmcnt(4)
    v_mfma_f32_32x32x16_bf16 v[16:31], v[48:51], v[160:163], v[16:31]
    v_mfma_f32_32x32x16_bf16 v[32:47], v[52:55], v[160:163], v[32:47]
    ds_read_b64_tr_b16 v[48:49], v4 offset:28672
    ds_read_b64_tr_b16 v[50:51], v4 offset:29696
    ds_read_b64_tr_b16 v[52:53], v5 offset:28672
    ds_read_b64_tr_b16 v[54:55], v5 offset:29696
    s_waitcnt vmcnt(2) lgkmcnt(4)
    v_mfma_f32_32x32x16_bf16 v[16:31], v[56:59], v[164:167], v[16:31]
    v_mfma_f32_32x32x16_bf16 v[32:47], v[60:63], v[164:167], v[32:47]
    v_max3_u32 v3, v3, v160, v164
    ds_read_b64_tr_b16 v[56:57], v4 offset:30720
    ds_read_b64_tr_b16 v[58:59], v4 offset:31744
    ds_read_b64_tr_b16 v[60:61], v5 offset:30720
    ds_read_b64_tr_b16 v[62:63], v5 offset:31744
    s_waitcnt vmcnt(1) lgkmcnt(4)
    v_mfma_f32_32x32x16_bf16 v[16:31], v[48:51], v[168:171], v[16:31]
    v_mfma_f32_32x32x16_bf16 v[32:47], v[52:55], v[168:171], v[32:47]
    s_waitcnt vmcnt(0) lgkmcnt(0)
    v_max3_u32 v3, v3, v168, v172
    v_cmp_eq_u32 vcc, -1, v3
    v_mfma_f32_32x32x16_bf16 v[32:47], v[60:63], v[172:175], v[32:47]
    v_mfma_f32_32x32x16_bf16 v[16:31], v[56:59], v[172:175], v[16:31]
    s_cbranch_vccz attn_kernel_tx
    s_cmp_gt_i32 s64, 0
    s_cbranch_scc0 attn_kernel_tx
    s_mov_b32 s65, 1
    s_nop 15
    v_mov_b64 v[16:17], 0
    v_mov_b64 v[18:19], 0
    v_mov_b64 v[20:21], 0
    v_mov_b64 v[22:23], 0
    v_mov_b64 v[24:25], 0
    v_mov_b64 v[26:27], 0
    v_mov_b64 v[28:29], 0
    v_mov_b64 v[30:31], 0
    v_mov_b64 v[32:33], 0
    v_mov_b64 v[34:35], 0
    v_mov_b64 v[36:37], 0
    v_mov_b64 v[38:39], 0
    v_mov_b64 v[40:41], 0
    v_mov_b64 v[42:43], 0
    v_mov_b64 v[44:45], 0
    v_mov_b64 v[46:47], 0
    s_branch attn_kernel_tr
attn_kernel_tx:
    s_nop 7
    ds_write_b128 v6, v[32:35] offset:0
    ds_write_b128 v6, v[36:39] offset:1024
    ds_write_b128 v6, v[40:43] offset:2048
    ds_write_b128 v6, v[44:47] offset:3072
    s_waitcnt lgkmcnt(0)
    s_barrier
    ds_read_b128 v[48:51], v7 offset:0
    ds_read_b128 v[52:55], v7 offset:1024
    ds_read_b128 v[56:59], v7 offset:2048
    ds_read_b128 v[60:63], v7 offset:3072
    s_waitcnt lgkmcnt(2)
    v_pk_add_f32 v[16:17], v[16:17], v[48:49]
    v_pk_add_f32 v[18:19], v[18:19], v[50:51]
    v_pk_add_f32 v[20:21], v[20:21], v[52:53]
    v_pk_add_f32 v[22:23], v[22:23], v[54:55]
    v_cvt_pk_bf16_f32 v68, v16, v17
    v_cvt_pk_bf16_f32 v69, v18, v19
    v_cvt_pk_bf16_f32 v70, v20, v21
    v_cvt_pk_bf16_f32 v71, v22, v23
    s_waitcnt lgkmcnt(0)
    v_pk_add_f32 v[24:25], v[24:25], v[56:57]
    v_pk_add_f32 v[26:27], v[26:27], v[58:59]
    v_pk_add_f32 v[28:29], v[28:29], v[60:61]
    v_pk_add_f32 v[30:31], v[30:31], v[62:63]
    v_cvt_pk_bf16_f32 v72, v24, v25
    v_cvt_pk_bf16_f32 v73, v26, v27
    v_cvt_pk_bf16_f32 v74, v28, v29
    v_cvt_pk_bf16_f32 v75, v30, v31
    ds_write_b128 v64, v[68:71]
    ds_write_b128 v65, v[72:75]
    s_waitcnt lgkmcnt(0)
    ds_read_b128 v[76:79], v66 offset:0
    ds_read_b128 v[80:83], v66 offset:1024
    s_add_u32 s63, s58, 0
    s_waitcnt lgkmcnt(1)
    buffer_store_dwordx4 v[76:79], v67, s[40:43], s63 offen sc0 sc1
    s_add_u32 s63, s58, 32768
    s_waitcnt lgkmcnt(0)
    buffer_store_dwordx4 v[80:83], v67, s[40:43], s63 offen sc0 sc1
attn_kernel_end:
    s_endpgm
attn_kernel_B_end0:
    s_nop 0
    v_smfmac_f32_32x32x32_bf16 v[64:79], v[152:155], v[24:31], v12
    s_branch attn_kernel_B_fin
attn_kernel_B_end1:
    s_nop 0
    v_smfmac_f32_32x32x32_bf16 v[64:79], v[160:163], v[40:47], v12
    s_branch attn_kernel_B_fin
attn_kernel_B_end2:
    s_nop 0
    v_smfmac_f32_32x32x32_bf16 v[64:79], v[168:171], v[24:31], v12
    s_branch attn_kernel_B_fin
attn_kernel_B_end3:
    s_nop 0
    v_smfmac_f32_32x32x32_bf16 v[64:79], v[176:179], v[40:47], v12
    s_branch attn_kernel_B_fin
attn_kernel_B_end4:
    s_nop 0
    v_smfmac_f32_32x32x32_bf16 v[64:79], v[184:187], v[24:31], v12
    s_branch attn_kernel_B_fin
attn_kernel_B_end5:
    s_nop 0
    v_smfmac_f32_32x32x32_bf16 v[64:79], v[192:195], v[40:47], v12
    s_branch attn_kernel_B_fin
attn_kernel_B_end6:
    s_nop 0
    v_smfmac_f32_32x32x32_bf16 v[64:79], v[200:203], v[24:31], v12
    s_branch attn_kernel_B_fin
attn_kernel_B_end7:
    s_nop 0
    v_smfmac_f32_32x32x32_bf16 v[64:79], v[208:211], v[40:47], v12
    s_branch attn_kernel_B_fin
attn_kernel_side:
    s_add_u32 s35, s35, 1
    s_cmp_eq_u32 s34, 1
    s_cbranch_scc1 attn_kernel_side1
    s_cmp_eq_u32 s34, 2
    s_cbranch_scc1 attn_kernel_side2
    s_cmp_eq_u32 s34, 3
    s_cbranch_scc1 attn_kernel_side3
    s_cmp_eq_u32 s34, 4
    s_cbranch_scc1 attn_kernel_side4
    s_cmp_eq_u32 s34, 5
    s_cbranch_scc1 attn_kernel_side5
    s_cmp_eq_u32 s34, 6
    s_cbranch_scc1 attn_kernel_side6
    s_cmp_eq_u32 s34, 7
    s_cbranch_scc1 attn_kernel_side7
    s_branch attn_kernel_A_cont
attn_kernel_side1:
    s_waitcnt vmcnt(0)
    s_barrier
    s_branch attn_kernel_A_cont
attn_kernel_side2:
    v_mov_b32 v220, -1
    v_mov_b32 v221, -1
    v_mov_b32 v222, -1
    v_mov_b32 v223, -1
    s_lshl_b32 s66, s8, 15
    s_lshl_b32 s67, s6, 10
    s_add_u32 s66, s66, s67
    s_add_u32 s67, s66, 0x900000
    buffer_store_dwordx4 v[220:223], v2, s[12:15], s67 offen sc0 sc1
    s_add_u32 s67, s66, 0xb00000
    buffer_store_dwordx4 v[220:223], v2, s[12:15], s67 offen sc0 sc1
    s_add_u32 s18, s10, 0x200000
    buffer_load_dwordx4 v[80:83], v2, s[12:15], s18 offen
    s_add_u32 s18, s19, 0x200000
    v_and_or_b32 v7, s18, v6, v4
    buffer_load_dwordx4 v[112:115], v2, s[12:15], s19 offen
    buffer_load_dwordx4 v[148:151], v7, s[12:15], 0 offen
    buffer_load_dwordx4 v[152:155], v7, s[12:15], 0 offen offset:512
    s_sub_u32 s19, s19, 0x400
    s_max_i32 s19, s19, s20
    s_add_u32 s18, s19, 0x200000
    v_and_or_b32 v7, s18, v6, v4
    buffer_load_dwordx4 v[116:119], v2, s[12:15], s19 offen
    buffer_load_dwordx4 v[156:159], v7, s[12:15], 0 offen
    buffer_load_dwordx4 v[160:163], v7, s[12:15], 0 offen offset:512
    s_sub_u32 s19, s19, 0x400
    s_max_i32 s19, s19, s20
    s_branch attn_kernel_A_cont
attn_kernel_side3:
    s_cmp_ge_u32 s7, 4
    s_cbranch_scc1 attn_kernel_side3b
    s_barrier
attn_kernel_side3b:
    s_add_u32 s18, s19, 0x200000
    v_and_or_b32 v7, s18, v6, v4
    buffer_load_dwordx4 v[120:123], v2, s[12:15], s19 offen
    buffer_load_dwordx4 v[164:167], v7, s[12:15], 0 offen
    buffer_load_dwordx4 v[168:171], v7, s[12:15], 0 offen offset:512
    s_sub_u32 s19, s19, 0x400
    s_max_i32 s19, s19, s20
    s_add_u32 s18, s19, 0x200000
    v_and_or_b32 v7, s18, v6, v4
    buffer_load_dwordx4 v[124:127], v2, s[12:15], s19 offen
    buffer_load_dwordx4 v[172:175], v7, s[12:15], 0 offen
    buffer_load_dwordx4 v[176:179], v7, s[12:15], 0 offen offset:512
    s_sub_u32 s19, s19, 0x400
    s_max_i32 s19, s19, s20
    s_branch attn_kernel_A_cont
attn_kernel_side4:
    s_lshr_b32 s67, s8, 1
    s_lshl_b32 s67, s67, 8
    s_add_u32 s67, s67, 0x824000
    s_waitcnt vmcnt(0)
    s_mov_b64 exec, 1
    v_mov_b32 v220, 1
    buffer_atomic_add v220, off, s[12:15], s67 sc1
    s_mov_b64 exec, -1
    s_add_u32 s18, s19, 0x200000
    v_and_or_b32 v7, s18, v6, v4
    buffer_load_dwordx4 v[128:131], v2, s[12:15], s19 offen
    buffer_load_dwordx4 v[180:183], v7, s[12:15], 0 offen
    buffer_load_dwordx4 v[184:187], v7, s[12:15], 0 offen offset:512
    s_sub_u32 s19, s19, 0x400
    s_max_i32 s19, s19, s20
    s_add_u32 s18, s19, 0x200000
    v_and_or_b32 v7, s18, v6, v4
    buffer_load_dwordx4 v[132:135], v2, s[12:15], s19 offen
    buffer_load_dwordx4 v[188:191], v7, s[12:15], 0 offen
    buffer_load_dwordx4 v[192:195], v7, s[12:15], 0 offen offset:512
    s_sub_u32 s19, s19, 0x400
    s_max_i32 s19, s19, s20
    s_branch attn_kernel_A_cont
attn_kernel_side5:
    s_add_u32 s18, s19, 0x200000
    v_and_or_b32 v7, s18, v6, v4
    buffer_load_dwordx4 v[136:139], v2, s[12:15], s19 offen
    buffer_load_dwordx4 v[196:199], v7, s[12:15], 0 offen
    buffer_load_dwordx4 v[200:203], v7, s[12:15], 0 offen offset:512
    s_sub_u32 s19, s19, 0x400
    s_max_i32 s19, s19, s20
    s_add_u32 s18, s19, 0x200000
    v_and_or_b32 v7, s18, v6, v4
    buffer_load_dwordx4 v[140:143], v2, s[12:15], s19 offen
    buffer_load_dwordx4 v[204:207], v7, s[12:15], 0 offen
    buffer_load_dwordx4 v[208:211], v7, s[12:15], 0 offen offset:512
    s_sub_u32 s19, s19, 0x400
    s_max_i32 s19, s19, s20
    s_branch attn_kernel_A_cont
attn_kernel_side6:
    s_add_u32 s18, s19, 0x200000
    v_and_or_b32 v7, s18, v6, v4
    buffer_load_dwordx4 v[144:147], v2, s[12:15], s19 offen
    buffer_load_dwordx4 v[212:215], v7, s[12:15], 0 offen
    buffer_load_dwordx4 v[216:219], v7, s[12:15], 0 offen offset:512
    s_mov_b32 s18, 0x820000
    buffer_load_dwordx4 v[220:223], v2, s[12:15], s18 offen offset:0
    s_mov_b32 s18, 0x820000
    buffer_load_dwordx4 v[224:227], v2, s[12:15], s18 offen offset:1024
    s_mov_b32 s18, 0x820000
    buffer_load_dwordx4 v[228:231], v2, s[12:15], s18 offen offset:2048
    s_mov_b32 s18, 0x820000
    buffer_load_dwordx4 v[232:235], v2, s[12:15], s18 offen offset:3072
    s_mov_b32 s18, 0x821000
    buffer_load_dwordx4 v[236:239], v2, s[12:15], s18 offen offset:0
    s_mov_b32 s18, 0x821000
    buffer_load_dwordx4 v[240:243], v2, s[12:15], s18 offen offset:1024
    s_mov_b32 s18, 0x821000
    buffer_load_dwordx4 v[244:247], v2, s[12:15], s18 offen offset:2048
    s_mov_b32 s18, 0x821000
    buffer_load_dwordx4 v[248:251], v2, s[12:15], s18 offen offset:3072
    s_branch attn_kernel_A_cont
attn_kernel_side7:
    s_cmp_ge_u32 s7, 4
    s_cbranch_scc1 attn_kernel_A_cont
    s_setprio 0
    s_branch attn_kernel_A_cont
attn_kernel_A_retry:
    s_mov_b32 s29, 1
    s_mov_b32 s34, 0
    v_mov_b32 v13, v2
    v_mov_b32 v10, 0xff800000
    v_mov_b64 v[32:33], 0
    v_mov_b64 v[34:35], 0
    v_mov_b64 v[36:37], 0
    v_mov_b64 v[38:39], 0
    v_mov_b64 v[40:41], 0
    v_mov_b64 v[42:43], 0
    v_mov_b64 v[44:45], 0
    v_mov_b64 v[46:47], 0
attn_kernel_A_rl:
    ds_read_b128 v[88:91], v13
    s_waitcnt lgkmcnt(0)
    v_mfma_f32_32x32x16_bf16 v[16:31], v[88:91], v[84:87], v[32:47]
    s_nop 15
    v_max3_f32 v8, v16, v17, v18
    v_max3_f32 v9, v19, v20, v21
    v_max3_f32 v8, v8, v22, v23
    v_max3_f32 v9, v9, v24, v25
    v_max3_f32 v8, v8, v26, v27
    v_max3_f32 v9, v9, v28, v29
    v_max3_f32 v8, v8, v30, v31
    v_max3_f32 v10, v8, v9, v10
    v_add_u32 v13, 1024, v13
    s_add_u32 s34, s34, 1
    s_cmp_lt_u32 s34, 64
    s_cbranch_scc1 attn_kernel_A_rl
    v_mov_b32 v8, v10
    s_nop 1
    v_permlane32_swap_b32 v8, v10
    s_nop 1
    v_max_f32 v10, v8, v10
    ds_read_b128 v[88:91], v2
    v_mov_b64 v[64:65], 0
    v_mov_b64 v[66:67], 0
    v_mov_b64 v[68:69], 0
    v_mov_b64 v[70:71], 0
    v_mov_b64 v[72:73], 0
    v_mov_b64 v[74:75], 0
    v_mov_b64 v[76:77], 0
    v_mov_b64 v[78:79], 0
    s_waitcnt lgkmcnt(0)
    s_branch attn_kernel_A_go
attn_kernel_B_retry:
    s_mov_b32 s29, 1
    v_mov_b32 v10, 0xff800000
    v_mfma_f32_32x32x16_bf16 v[16:31], v[112:115], v[80:83], v[220:235]
    s_nop 15
    v_max3_f32 v8, v16, v17, v18
    v_max3_f32 v9, v19, v20, v21
    v_max3_f32 v8, v8, v22, v23
    v_max3_f32 v9, v9, v24, v25
    v_max3_f32 v8, v8, v26, v27
    v_max3_f32 v9, v9, v28, v29
    v_max3_f32 v8, v8, v30, v31
    v_max3_f32 v10, v8, v9, v10
    s_cmp_eq_u32 s28, 0
    s_cbranch_scc1 attn_kernel_B_rd
    v_mfma_f32_32x32x16_bf16 v[16:31], v[116:119], v[80:83], v[48:63]
    s_nop 15
    v_max3_f32 v8, v16, v17, v18
    v_max3_f32 v9, v19, v20, v21
    v_max3_f32 v8, v8, v22, v23
    v_max3_f32 v9, v9, v24, v25
    v_max3_f32 v8, v8, v26, v27
    v_max3_f32 v9, v9, v28, v29
    v_max3_f32 v8, v8, v30, v31
    v_max3_f32 v10, v8, v9, v10
    s_cmp_eq_u32 s28, 1
    s_cbranch_scc1 attn_kernel_B_rd
    v_mfma_f32_32x32x16_bf16 v[16:31], v[120:123], v[80:83], v[48:63]
    s_nop 15
    v_max3_f32 v8, v16, v17, v18
    v_max3_f32 v9, v19, v20, v21
    v_max3_f32 v8, v8, v22, v23
    v_max3_f32 v9, v9, v24, v25
    v_max3_f32 v8, v8, v26, v27
    v_max3_f32 v9, v9, v28, v29
    v_max3_f32 v8, v8, v30, v31
    v_max3_f32 v10, v8, v9, v10
    s_cmp_eq_u32 s28, 2
    s_cbranch_scc1 attn_kernel_B_rd
    v_mfma_f32_32x32x16_bf16 v[16:31], v[124:127], v[80:83], v[48:63]
    s_nop 15
    v_max3_f32 v8, v16, v17, v18
    v_max3_f32 v9, v19, v20, v21
    v_max3_f32 v8, v8, v22, v23
    v_max3_f32 v9, v9, v24, v25
    v_max3_f32 v8, v8, v26, v27
    v_max3_f32 v9, v9, v28, v29
    v_max3_f32 v8, v8, v30, v31
    v_max3_f32 v10, v8, v9, v10
    s_cmp_eq_u32 s28, 3
    s_cbranch_scc1 attn_kernel_B_rd
    v_mfma_f32_32x32x16_bf16 v[16:31], v[128:131], v[80:83], v[48:63]
    s_nop 15
    v_max3_f32 v8, v16, v17, v18
    v_max3_f32 v9, v19, v20, v21
    v_max3_f32 v8, v8, v22, v23
    v_max3_f32 v9, v9, v24, v25
    v_max3_f32 v8, v8, v26, v27
    v_max3_f32 v9, v9, v28, v29
    v_max3_f32 v8, v8, v30, v31
    v_max3_f32 v10, v8, v9, v10
    s_cmp_eq_u32 s28, 4
    s_cbranch_scc1 attn_kernel_B_rd
    v_mfma_f32_32x32x16_bf16 v[16:31], v[132:135], v[80:83], v[48:63]
    s_nop 15
    v_max3_f32 v8, v16, v17, v18
    v_max3_f32 v9, v19, v20, v21
    v_max3_f32 v8, v8, v22, v23
    v_max3_f32 v9, v9, v24, v25
    v_max3_f32 v8, v8, v26, v27
    v_max3_f32 v9, v9, v28, v29
    v_max3_f32 v8, v8, v30, v31
    v_max3_f32 v10, v8, v9, v10
    s_cmp_eq_u32 s28, 5
    s_cbranch_scc1 attn_kernel_B_rd
    v_mfma_f32_32x32x16_bf16 v[16:31], v[136:139], v[80:83], v[48:63]
    s_nop 15
    v_max3_f32 v8, v16, v17, v18
    v_max3_f32 v9, v19, v20, v21
    v_max3_f32 v8, v8, v22, v23
    v_max3_f32 v9, v9, v24, v25
    v_max3_f32 v8, v8, v26, v27
    v_max3_f32 v9, v9, v28, v29
    v_max3_f32 v8, v8, v30, v31
    v_max3_f32 v10, v8, v9, v10
    s_cmp_eq_u32 s28, 6
    s_cbranch_scc1 attn_kernel_B_rd
    v_mfma_f32_32x32x16_bf16 v[16:31], v[140:143], v[80:83], v[48:63]
    s_nop 15
    v_max3_f32 v8, v16, v17, v18
    v_max3_f32 v9, v19, v20, v21
    v_max3_f32 v8, v8, v22, v23
    v_max3_f32 v9, v9, v24, v25
    v_max3_f32 v8, v8, v26, v27
    v_max3_f32 v9, v9, v28, v29
    v_max3_f32 v8, v8, v30, v31
    v_max3_f32 v10, v8, v9, v10
    s_cmp_eq_u32 s28, 7
    s_cbranch_scc1 attn_kernel_B_rd
    v_mfma_f32_32x32x16_bf16 v[16:31], v[144:147], v[80:83], v[236:251]
    s_nop 15
    v_max3_f32 v8, v16, v17, v18
    v_max3_f32 v9, v19, v20, v21
    v_max3_f32 v8, v8, v22, v23
    v_max3_f32 v9, v9, v24, v25
    v_max3_f32 v8, v8, v26, v27
    v_max3_f32 v9, v9, v28, v29
    v_max3_f32 v8, v8, v30, v31
    v_max3_f32 v10, v8, v9, v10
attn_kernel_B_rd:
    v_mov_b32 v8, v10
    s_nop 1
    v_permlane32_swap_b32 v8, v10
    s_nop 1
    v_max_f32 v10, v8, v10
    s_nop 7
    v_sub_f32 v48, 0, v10
    v_sub_f32 v220, v220, v10
    v_sub_f32 v236, v236, v10
    v_sub_f32 v49, 0, v10
    v_sub_f32 v221, v221, v10
    v_sub_f32 v237, v237, v10
    v_sub_f32 v50, 0, v10
    v_sub_f32 v222, v222, v10
    v_sub_f32 v238, v238, v10
    v_sub_f32 v51, 0, v10
    v_sub_f32 v223, v223, v10
    v_sub_f32 v239, v239, v10
    v_sub_f32 v52, 0, v10
    v_sub_f32 v224, v224, v10
    v_sub_f32 v240, v240, v10
    v_sub_f32 v53, 0, v10
    v_sub_f32 v225, v225, v10
    v_sub_f32 v241, v241, v10
    v_sub_f32 v54, 0, v10
    v_sub_f32 v226, v226, v10
    v_sub_f32 v242, v242, v10
    v_sub_f32 v55, 0, v10
    v_sub_f32 v227, v227, v10
    v_sub_f32 v243, v243, v10
    v_sub_f32 v56, 0, v10
    v_sub_f32 v228, v228, v10
    v_sub_f32 v244, v244, v10
    v_sub_f32 v57, 0, v10
    v_sub_f32 v229, v229, v10
    v_sub_f32 v245, v245, v10
    v_sub_f32 v58, 0, v10
    v_sub_f32 v230, v230, v10
    v_sub_f32 v246, v246, v10
    v_sub_f32 v59, 0, v10
    v_sub_f32 v231, v231, v10
    v_sub_f32 v247, v247, v10
    v_sub_f32 v60, 0, v10
    v_sub_f32 v232, v232, v10
    v_sub_f32 v248, v248, v10
    v_sub_f32 v61, 0, v10
    v_sub_f32 v233, v233, v10
    v_sub_f32 v249, v249, v10
    v_sub_f32 v62, 0, v10
    v_sub_f32 v234, v234, v10
    v_sub_f32 v250, v250, v10
    v_sub_f32 v63, 0, v10
    v_sub_f32 v235, v235, v10
    v_sub_f32 v251, v251, v10
    s_branch attn_kernel_B
.section .rodata,"a"
.p2align 6
.amdhsa_kernel proj_kernel
  .amdhsa_next_free_vgpr 152
  .amdhsa_next_free_sgpr 96
  .amdhsa_accum_offset 152
  .amdhsa_group_segment_fixed_size 0
  .amdhsa_kernarg_size 88
  .amdhsa_user_sgpr_count 2
  .amdhsa_user_sgpr_kernarg_segment_ptr 1
  .amdhsa_system_sgpr_workgroup_id_x 1
.end_amdhsa_kernel
.p2align 6
.amdhsa_kernel attn_kernel
  .amdhsa_next_free_vgpr 256
  .amdhsa_next_free_sgpr 96
  .amdhsa_accum_offset 256
  .amdhsa_group_segment_fixed_size 0
  .amdhsa_kernarg_size 88
  .amdhsa_user_sgpr_count 2
  .amdhsa_user_sgpr_kernarg_segment_ptr 1
  .amdhsa_system_sgpr_workgroup_id_x 1
.end_amdhsa_kernel
```
